```python
import torch

def _softmax(x, axis=-1):
    return torch.softmax(x, dim=axis)
def _gelu(x):
    return torch.nn.functional.gelu(x, approximate="tanh")
def _silu(x):
    return torch.nn.functional.silu(x)
def _sigmoid(x):
    return torch.sigmoid(x)
def _layernorm(x, axis=-1, eps=1e-5):
    m = x.mean(dim=axis, keepdim=True)
    v = x.var(dim=axis, keepdim=True, unbiased=False)
    return (x - m) / torch.sqrt(v + eps)
def _scatter_add(tgt, idx, src, axis=0):
    return tgt.clone().index_add_(axis, idx, src)
def _segment_sum(src, seg, n):
    out = torch.zeros((n,) + src.shape[1:], dtype=src.dtype)
    return out.index_add_(0, seg, src)
def _pad(x, pw):
    flat = tuple(v for pair in reversed(pw) for v in pair)
    return torch.nn.functional.pad(x, flat)

kernel_name = 'parallel_sum__grouped_kv_mqa__dense_activation_silu__prompt'

def setup_inputs():

    _w = (lambda a: (lambda t: t.to(torch.bfloat16) if t.is_floating_point() else t)(torch.as_tensor(a)))
    def _A_setup():
        B, S, D, H = 1, 2048, 512, 32
        Dh = D // H
        return {
            "x": _w((lambda *s: torch.randn(*s, dtype=torch.bfloat16) * 0.05)(B, S, D)),
            "wq": _w((lambda *s: torch.randn(*s, dtype=torch.bfloat16) * 0.05)(D, H * Dh)),
            "wk": _w((lambda *s: torch.randn(*s, dtype=torch.bfloat16) * 0.05)(D, Dh)),
            "wv": _w((lambda *s: torch.randn(*s, dtype=torch.bfloat16) * 0.05)(D, Dh)),
            "wo": _w((lambda *s: torch.randn(*s, dtype=torch.bfloat16) * 0.05)(H * Dh, D)),
        }
    _A_in = _A_setup()

    def _B_setup():
        B, S, D, F = 1, 2048, 512, 1376
        return {
            "x": _w((lambda *s: torch.randn(*s, dtype=torch.bfloat16) * 0.05)(B, S, D)),
            "w1": _w((lambda *s: torch.randn(*s, dtype=torch.bfloat16) * 0.8)(D, F) * (D ** -0.5)),
            "w2": _w((lambda *s: torch.randn(*s, dtype=torch.bfloat16) * 0.2)(F, D) * (F ** -0.5)),
        }
    _B_in = _B_setup()

    return {
        "A_x": _A_in["x"],
        "A_wq": _A_in["wq"],
        "A_wk": _A_in["wk"],
        "A_wv": _A_in["wv"],
        "A_wo": _A_in["wo"],
        "B_x": _B_in["x"],
        "B_w1": _B_in["w1"],
        "B_w2": _B_in["w2"],
    }

def reference(A_x, A_wq, A_wk, A_wv, A_wo, B_x, B_w1, B_w2):
    def _A_ref(x, wq, wk, wv, wo):
        B, S, D = x.shape
        H = 32
        Dh = D // H
        q = (lambda x, *d: x.permute(*d))((x @ wq).reshape(B, S, H, Dh), 0, 2, 1, 3)
        k = x @ wk
        v = x @ wv
        scores = torch.einsum("bhqd,bkd->bhqk", q, k) * (Dh ** -0.5)
        p = _softmax(scores, axis=-1)
        o = torch.einsum("bhqk,bkd->bhqd", p, v)
        return (lambda x, *d: x.permute(*d))(o, 0, 2, 1, 3).reshape(B, S, H * Dh) @ wo

    def _B_ref(x, w1, w2):
        h = torch.einsum("bsd,df->bsf", x, w1)
        h = _silu(h)
        out = torch.einsum("bsf,fd->bsd", h, w2)
        return out

    x = A_x
    xn = _layernorm(x, axis=-1)
    return x + _A_ref(xn, A_wq, A_wk, A_wv, A_wo) + _B_ref(xn, B_w1, B_w2)
```

```asm
; @launch grid=(256,1,1) block=(512,1,1) lds=163840
.amdgcn_target "amdgcn-amd-amdhsa--gfx950"
.text
.globl parallel_sum__grouped_kv_mqa__dense_activation_silu__prompt_kernel
.p2align 12
.p2align 8
.type parallel_sum__grouped_kv_mqa__dense_activation_silu__prompt_kernel,@function
parallel_sum__grouped_kv_mqa__dense_activation_silu__prompt_kernel:
    s_cmp_ge_u32 s2, 256
    s_cbranch_scc1 L_end
    s_load_dwordx2 s[28:29], s[0:1], 0
    s_load_dwordx2 s[32:33], s[0:1], 8
    s_load_dwordx16 s[48:63], s[0:1], 16
    s_load_dwordx2 s[64:65], s[0:1], 80
    v_readfirstlane_b32 s97, v0
    s_mov_b64 exec, 0
    s_cmp_eq_u32 s97, 384
    s_cbranch_scc1 L_gcont
    s_cmp_eq_u32 s97, 448
    s_cbranch_scc1 L_a2
L_rt0:
    s_mov_b64 exec, -1
    s_lshr_b32 s98, s2, 3
    s_and_b32 s97, s2, 7
    v_lshrrev_b32 v1, 6, v0
    v_and_b32 v0, 63, v0
    v_mov_b32 v9, 106496
    v_readfirstlane_b32 s26, v1
    v_mov_b32 v6, 0
    v_lshl_add_u32 v7, v0, 2, v9
    ds_write_b32 v7, v6
    s_and_b32 s3, s98, 7
    s_lshr_b32 s24, s98, 3
    s_lshl_b32 s27, s97, 2
    s_add_u32 s27, s27, s24
    s_lshl_b32 s96, s24, 2
    s_lshr_b32 s97, s97, 1
    s_or_b32 s96, s96, s97
    s_xor_b32 s99, s3, s26
    v_lshrrev_b32 v4, 3, v0
    v_and_b32 v5, 7, v0
    v_lshlrev_b32 v63, 10, v4
    v_lshl_add_u32 v63, v5, 4, v63
    s_lshl_b32 s100, s27, 16
    s_lshl_b32 s98, s99, 13
    s_add_u32 s100, s100, s98
    s_and_b32 s98, s3, 1
    s_lshl_b32 s98, s98, 9
    s_add_u32 s100, s100, s98
    s_lshl_b32 s98, s24, 7
    s_add_u32 s100, s100, s98
    s_mov_b32 s30, 2097152
    s_mov_b32 s31, 0x00020000
    s_mov_b32 s34, 524288
    s_mov_b32 s35, 0x00020000
    s_mov_b32 s66, 10485760
    s_mov_b32 s67, 0x00020000
    s_and_b32 s18, s26, 3
    s_and_b32 s12, s26, 1
    s_lshr_b32 s11, s18, 1
    s_mov_b32 s10, 1048576
    s_mov_b32 s19, 0x3f803f80
    v_lshlrev_b32 v8, 4, v0
    v_mov_b32 v2, 1
    s_lshl_b32 s97, s12, 2
    v_add_u32 v10, s97, v9
    s_and_b32 s97, s99, 3
    s_lshl_b32 s97, s97, 3
    s_lshr_b32 s98, s99, 2
    s_lshl_b32 s98, s98, 15
    s_and_b32 s99, s3, 1
    s_lshl_b32 s99, s99, 14
    s_add_u32 s98, s98, s99
    v_add_u32 v7, s97, v4
    v_xor_b32 v7, v7, v5
    v_lshlrev_b32 v7, 4, v7
    v_lshl_add_u32 v7, v5, 9, v7
    v_add_u32 v68, s98, v7
    s_cmp_ge_u32 s26, 4
    s_cbranch_scc1 L_awave
    s_mul_i32 s13, s18, 12288
    s_add_u32 s13, s13, 107520
    s_mov_b32 m0, s13
    v_bfe_u32 v4, v0, 4, 1
    v_lshlrev_b32 v4, 7, v4
    v_xor_b32 v4, v4, v8
    s_lshl_b32 s4, s18, 1
    s_xor_b32 s4, s4, s24
    s_lshl_b32 s4, s4, 11
    s_and_b32 s5, s3, 1
    s_waitcnt lgkmcnt(0)
    s_cselect_b64 s[36:37], s[50:51], s[48:49]
    s_mov_b32 s38, 16384
    s_mov_b32 s39, 0x00020000
    buffer_load_dwordx4 v4, s[36:39], s4 offen offset:0 lds
    buffer_load_dwordx4 v4, s[36:39], s4 offen offset:1024 lds
    s_add_u32 m0, s13, 2048
    s_xor_b32 s4, s4, 2048
    buffer_load_dwordx4 v4, s[36:39], s4 offen offset:0 lds
    buffer_load_dwordx4 v4, s[36:39], s4 offen offset:1024 lds
    buffer_load_dwordx4 v[16:19], v63, s[28:31], s100 offen
    s_xor_b32 s101, s100, 128
    buffer_load_dwordx4 v[20:23], v63, s[28:31], s101 offen
    s_xor_b32 s101, s100, 256
    buffer_load_dwordx4 v[24:27], v63, s[28:31], s101 offen
    s_xor_b32 s101, s100, 384
    buffer_load_dwordx4 v[28:31], v63, s[28:31], s101 offen
    s_xor_b32 s101, s100, 512
    buffer_load_dwordx4 v[32:35], v63, s[28:31], s101 offen
    s_xor_b32 s101, s100, 640
    buffer_load_dwordx4 v[36:39], v63, s[28:31], s101 offen
    s_xor_b32 s101, s100, 768
    buffer_load_dwordx4 v[40:43], v63, s[28:31], s101 offen
    s_xor_b32 s101, s100, 896
    buffer_load_dwordx4 v[44:47], v63, s[28:31], s101 offen
    s_mov_b32 s98, 9404416
    s_mov_b64 exec, 1
    s_cmp_eq_u32 s26, 0
    s_cselect_b32 s98, s98, 2147418112
    buffer_load_dword v71, off, s[64:67], s98 sc1
    s_mov_b64 exec, -1
    s_branch L_gcont
L_awave:
    s_lshl_b32 s13, s18, 13
    s_add_u32 s13, s13, 65536
    v_lshrrev_b32 v4, 2, v0
    v_and_b32 v5, 3, v0
    v_lshlrev_b32 v69, 10, v4
    v_lshl_add_u32 v69, v5, 4, v69
    s_lshl_b32 s6, s11, 18
    s_lshl_b32 s4, s3, 7
    s_add_u32 s6, s6, s4
    s_lshl_b32 s4, s12, 6
    s_add_u32 s6, s6, s4
    s_lshl_b32 s4, s96, 14
    s_add_u32 s6, s6, s4
    v_and_b32 v4, 31, v0
    v_lshrrev_b32 v5, 5, v0
    s_mul_i32 s4, s11, 49152
    s_xor_b32 s5, s96, 0
    s_and_b32 s5, s5, 3
    s_lshl_b32 s9, s5, 10
    s_add_u32 s9, s9, s4
    s_lshl_b32 s5, s5, 1
    v_or_b32 v6, s5, v5
    v_xor_b32 v6, v6, v4
    v_lshlrev_b32 v6, 4, v6
    v_lshl_add_u32 v6, v5, 9, v6
    v_add_u32 v72, s9, v6
    v_xor_b32 v76, 0x8000, v72
    s_xor_b32 s5, s96, 1
    s_and_b32 s5, s5, 3
    s_lshl_b32 s9, s5, 10
    s_add_u32 s9, s9, s4
    s_lshl_b32 s5, s5, 1
    v_or_b32 v6, s5, v5
    v_xor_b32 v6, v6, v4
    v_lshlrev_b32 v6, 4, v6
    v_lshl_add_u32 v6, v5, 9, v6
    v_add_u32 v73, s9, v6
    v_xor_b32 v77, 0x8000, v73
    s_xor_b32 s5, s96, 2
    s_and_b32 s5, s5, 3
    s_lshl_b32 s9, s5, 10
    s_add_u32 s9, s9, s4
    s_lshl_b32 s5, s5, 1
    v_or_b32 v6, s5, v5
    v_xor_b32 v6, v6, v4
    v_lshlrev_b32 v6, 4, v6
    v_lshl_add_u32 v6, v5, 9, v6
    v_add_u32 v74, s9, v6
    v_xor_b32 v78, 0x8000, v74
    s_xor_b32 s5, s96, 3
    s_and_b32 s5, s5, 3
    s_lshl_b32 s9, s5, 10
    s_add_u32 s9, s9, s4
    s_lshl_b32 s5, s5, 1
    v_or_b32 v6, s5, v5
    v_xor_b32 v6, v6, v4
    v_lshlrev_b32 v6, 4, v6
    v_lshl_add_u32 v6, v5, 9, v6
    v_add_u32 v75, s9, v6
    v_xor_b32 v79, 0x8000, v75
    v_bfe_u32 v4, v0, 2, 2
    v_lshrrev_b32 v5, 5, v0
    v_and_b32 v6, 3, v0
    v_lshlrev_b32 v6, 3, v6
    v_bfe_u32 v7, v0, 4, 1
    v_lshl_add_u32 v6, v7, 5, v6
    v_lshl_add_u32 v4, v5, 3, v4
    v_lshl_add_u32 v70, v4, 6, v6
    s_mul_i32 s4, s18, 12288
    s_add_u32 s4, s4, 107520
    v_add_u32 v80, s4, v70
    s_lshl_b32 s4, s18, 2
    v_add_u32 v81, s4, v9
    v_add_u32 v70, s13, v70
    v_mov_b32 v3, 0xdddddddd
    s_mov_b32 s16, 0x0000ffff
    s_mov_b32 s17, 0x0000ffff
    s_mov_b32 vcc_lo, 0x00110000
    s_mov_b32 vcc_hi, 0x00110000
    v_mov_b32 v4, 0x3f803f80
    v_cndmask_b32 v4, 0, v4, vcc
    v_mov_b32 v84, v4
    v_mov_b32 v85, v4
    v_mov_b32 v86, v4
    v_mov_b32 v87, v4
    v_mov_b32 v88, v4
    v_mov_b32 v89, v4
    v_mov_b32 v90, v4
    v_mov_b32 v91, v4
    v_mov_b32 v96, v4
    v_mov_b32 v97, v4
    v_mov_b32 v98, v4
    v_mov_b32 v99, v4
    v_mov_b32 v100, v4
    v_mov_b32 v101, v4
    v_mov_b32 v102, v4
    v_mov_b32 v103, v4
    v_mov_b32 v108, v4
    v_mov_b32 v109, v4
    v_mov_b32 v110, v4
    v_mov_b32 v111, v4
    v_mov_b32 v112, v4
    v_mov_b32 v113, v4
    v_mov_b32 v114, v4
    v_mov_b32 v115, v4
    v_mov_b32 v120, v4
    v_mov_b32 v121, v4
    v_mov_b32 v122, v4
    v_mov_b32 v123, v4
    v_mov_b32 v124, v4
    v_mov_b32 v125, v4
    v_mov_b32 v126, v4
    v_mov_b32 v127, v4
    v_and_b32 v4, 15, v0
    v_lshrrev_b32 v5, 5, v0
    v_lshl_add_u32 v4, v5, 4, v4
    v_lshlrev_b32 v11, 4, v4
    s_lshr_b32 s4, s27, 2
    v_lshrrev_b32 v4, 3, v0
    v_add_u32 v4, s4, v4
    v_and_b32 v4, 7, v4
    v_lshlrev_b32 v4, 10, v4
    v_bfe_u32 v5, v0, 2, 1
    v_lshl_add_u32 v4, v5, 7, v4
    v_and_b32 v5, 3, v0
    v_lshl_add_u32 v107, v5, 2, v4
    s_lshl_b32 s20, s18, 8
    s_add_u32 s20, s20, 9388032
    s_lshl_b32 s4, s4, 14
    s_lshl_b32 s40, s18, 12
    s_add_u32 s40, s40, s4
    s_add_u32 s41, s40, 16384
    s_and_b32 s41, s41, 0x1ffff
    s_add_u32 s42, s40, 32768
    s_and_b32 s42, s42, 0x1ffff
    s_add_u32 s43, s40, 49152
    s_and_b32 s43, s43, 0x1ffff
    s_add_u32 s44, s40, 65536
    s_and_b32 s44, s44, 0x1ffff
    s_add_u32 s45, s40, 81920
    s_and_b32 s45, s45, 0x1ffff
    s_add_u32 s46, s40, 98304
    s_and_b32 s46, s46, 0x1ffff
    s_add_u32 s47, s40, 114688
    s_and_b32 s47, s47, 0x1ffff
    s_lshl_b32 s4, s18, 11
    s_add_u32 s4, s4, 98304
    v_add_u32 v104, s13, v8
    v_xor_b32 v105, 0x4000, v104
    v_add_u32 v106, s4, v8
    v_xor_b32 v116, 6144, v106
    v_xor_b32 v117, 4096, v106
    v_xor_b32 v118, 2048, v106
    s_mul_i32 s4, s18, 13824
    s_add_u32 s4, s4, 107520
    v_add_u32 v12, s4, v8
    v_lshlrev_b32 v119, 2, v0
    v_add_u32 v13, s4, v119
    s_xor_b32 s4, s18, 1
    s_mul_i32 s4, s4, 13824
    s_add_u32 s4, s4, 116736
    v_add_u32 v4, s4, v8
    v_add_u32 v7, s4, v119
    s_xor_b32 s4, s18, 2
    s_mul_i32 s4, s4, 13824
    s_add_u32 s4, s4, 112128
    v_add_u32 v5, s4, v8
    v_add_u32 v14, s4, v119
    s_xor_b32 s4, s18, 3
    s_mul_i32 s4, s4, 13824
    s_add_u32 s4, s4, 107520
    v_add_u32 v6, s4, v8
    v_add_u32 v15, s4, v119
    s_lshl_b32 s7, s27, 16
    s_lshl_b32 s5, s3, 12
    s_add_u32 s7, s7, s5
    s_lshl_b32 s5, s12, 11
    s_add_u32 s7, s7, s5
    s_lshl_b32 s5, s11, 15
    s_add_u32 s7, s7, s5
    s_add_u32 s7, s7, 131072
    s_mov_b32 s21, 0x2b800000
    s_mov_b32 s22, 671088640
    v_mov_b32 v64, 0
    v_mov_b32 v65, 0
    v_mov_b32 v66, 0
    v_mov_b32 v67, 0
    s_waitcnt lgkmcnt(0)
    s_barrier
    buffer_load_dwordx4 v[16:19], v63, s[28:31], s100 offen
    s_xor_b32 s101, s100, 128
    buffer_load_dwordx4 v[20:23], v63, s[28:31], s101 offen
    s_xor_b32 s101, s100, 256
    buffer_load_dwordx4 v[24:27], v63, s[28:31], s101 offen
    s_xor_b32 s101, s100, 384
    buffer_load_dwordx4 v[28:31], v63, s[28:31], s101 offen
    s_xor_b32 s101, s100, 512
    buffer_load_dwordx4 v[32:35], v63, s[28:31], s101 offen
    s_xor_b32 s101, s100, 640
    buffer_load_dwordx4 v[36:39], v63, s[28:31], s101 offen
    s_xor_b32 s101, s100, 768
    buffer_load_dwordx4 v[40:43], v63, s[28:31], s101 offen
    s_xor_b32 s101, s100, 896
    buffer_load_dwordx4 v[44:47], v63, s[28:31], s101 offen
    s_branch L_a2
    .p2align 12
L_a2:
    s_cbranch_execz L_rt0
    s_waitcnt vmcnt(7)
    v_dot2c_f32_bf16 v64, s19, v16
    v_dot2c_f32_bf16 v66, v16, v16
    v_dot2c_f32_bf16 v65, s19, v17
    v_dot2c_f32_bf16 v67, v17, v17
    v_dot2c_f32_bf16 v64, s19, v18
    v_dot2c_f32_bf16 v66, v18, v18
    v_dot2c_f32_bf16 v65, s19, v19
    v_dot2c_f32_bf16 v67, v19, v19
    s_add_u32 m0, s13, 0
    s_xor_b32 s15, s6, 0
    buffer_load_dwordx4 v69, s[32:35], s15 offen lds
    s_waitcnt vmcnt(7)
    v_dot2c_f32_bf16 v64, s19, v20
    v_dot2c_f32_bf16 v66, v20, v20
    v_dot2c_f32_bf16 v65, s19, v21
    v_dot2c_f32_bf16 v67, v21, v21
    v_dot2c_f32_bf16 v64, s19, v22
    v_dot2c_f32_bf16 v66, v22, v22
    v_dot2c_f32_bf16 v65, s19, v23
    v_dot2c_f32_bf16 v67, v23, v23
    s_add_u32 m0, s13, 1024
    s_xor_b32 s15, s6, 16384
    buffer_load_dwordx4 v69, s[32:35], s15 offen lds
    s_waitcnt vmcnt(7)
    v_dot2c_f32_bf16 v64, s19, v24
    v_dot2c_f32_bf16 v66, v24, v24
    v_dot2c_f32_bf16 v65, s19, v25
    v_dot2c_f32_bf16 v67, v25, v25
    v_dot2c_f32_bf16 v64, s19, v26
    v_dot2c_f32_bf16 v66, v26, v26
    v_dot2c_f32_bf16 v65, s19, v27
    v_dot2c_f32_bf16 v67, v27, v27
    s_add_u32 m0, s13, 2048
    s_xor_b32 s15, s6, 32768
    buffer_load_dwordx4 v69, s[32:35], s15 offen lds
    s_waitcnt vmcnt(7)
    v_dot2c_f32_bf16 v64, s19, v28
    v_dot2c_f32_bf16 v66, v28, v28
    v_dot2c_f32_bf16 v65, s19, v29
    v_dot2c_f32_bf16 v67, v29, v29
    v_dot2c_f32_bf16 v64, s19, v30
    v_dot2c_f32_bf16 v66, v30, v30
    v_dot2c_f32_bf16 v65, s19, v31
    v_dot2c_f32_bf16 v67, v31, v31
    s_add_u32 m0, s13, 3072
    s_xor_b32 s15, s6, 49152
    buffer_load_dwordx4 v69, s[32:35], s15 offen lds
    s_waitcnt vmcnt(7)
    v_dot2c_f32_bf16 v64, s19, v32
    v_dot2c_f32_bf16 v66, v32, v32
    v_dot2c_f32_bf16 v65, s19, v33
    v_dot2c_f32_bf16 v67, v33, v33
    v_dot2c_f32_bf16 v64, s19, v34
    v_dot2c_f32_bf16 v66, v34, v34
    v_dot2c_f32_bf16 v65, s19, v35
    v_dot2c_f32_bf16 v67, v35, v35
    s_add_u32 m0, s13, 4096
    s_xor_b32 s15, s6, 65536
    buffer_load_dwordx4 v69, s[32:35], s15 offen lds
    s_waitcnt vmcnt(7)
    v_dot2c_f32_bf16 v64, s19, v36
    v_dot2c_f32_bf16 v66, v36, v36
    v_dot2c_f32_bf16 v65, s19, v37
    v_dot2c_f32_bf16 v67, v37, v37
    v_dot2c_f32_bf16 v64, s19, v38
    v_dot2c_f32_bf16 v66, v38, v38
    v_dot2c_f32_bf16 v65, s19, v39
    v_dot2c_f32_bf16 v67, v39, v39
    s_add_u32 m0, s13, 5120
    s_xor_b32 s15, s6, 81920
    buffer_load_dwordx4 v69, s[32:35], s15 offen lds
    s_waitcnt vmcnt(7)
    v_dot2c_f32_bf16 v64, s19, v40
    v_dot2c_f32_bf16 v66, v40, v40
    v_dot2c_f32_bf16 v65, s19, v41
    v_dot2c_f32_bf16 v67, v41, v41
    v_dot2c_f32_bf16 v64, s19, v42
    v_dot2c_f32_bf16 v66, v42, v42
    v_dot2c_f32_bf16 v65, s19, v43
    v_dot2c_f32_bf16 v67, v43, v43
    s_add_u32 m0, s13, 6144
    s_xor_b32 s15, s6, 98304
    buffer_load_dwordx4 v69, s[32:35], s15 offen lds
    s_waitcnt vmcnt(7)
    v_dot2c_f32_bf16 v64, s19, v44
    v_dot2c_f32_bf16 v66, v44, v44
    v_dot2c_f32_bf16 v65, s19, v45
    v_dot2c_f32_bf16 v67, v45, v45
    v_dot2c_f32_bf16 v64, s19, v46
    v_dot2c_f32_bf16 v66, v46, v46
    v_dot2c_f32_bf16 v65, s19, v47
    v_dot2c_f32_bf16 v67, v47, v47
    s_add_u32 m0, s13, 7168
    s_xor_b32 s15, s6, 114688
    buffer_load_dwordx4 v69, s[32:35], s15 offen lds
    s_nop 2
    v_add_f32 v64, v64, v65
    v_add_f32 v66, v66, v67
    s_nop 0
    v_add_f32_dpp v64, v64, v64 quad_perm:[1,0,3,2] row_mask:0xf bank_mask:0xf
    v_add_f32_dpp v66, v66, v66 quad_perm:[1,0,3,2] row_mask:0xf bank_mask:0xf
    s_nop 0
    v_add_f32_dpp v64, v64, v64 quad_perm:[2,3,0,1] row_mask:0xf bank_mask:0xf
    v_add_f32_dpp v66, v66, v66 quad_perm:[2,3,0,1] row_mask:0xf bank_mask:0xf
    s_nop 0
    v_add_f32_dpp v64, v64, v64 row_half_mirror row_mask:0xf bank_mask:0xf
    v_add_f32_dpp v66, v66, v66 row_half_mirror row_mask:0xf bank_mask:0xf
    v_mul_f32 v64, 0xbb000000, v64
    v_mul_f32 v66, 0x3b000000, v66
    v_fma_f32 v66, -v64, v64, v66
    v_max_f32 v66, 0, v66
    v_cvt_pk_bf16_f32 v66, 0, v66
    v_add_f32 v66, 0x3727c5ac, v66
    v_cvt_pk_bf16_f32 v66, 0, v66
    v_sqrt_f32 v66, v66
    v_cvt_pk_bf16_f32 v65, v64, v64
    v_cvt_pk_bf16_f32 v66, 0, v66
    v_rcp_f32 v66, v66
    v_and_b32 v64, 0xffff0000, v65
    v_mul_f32 v66, 0xbfb8aa3b, v66
    v_cvt_pk_bf16_f32 v67, 0, v66
    v_cvt_pk_bf16_f32 v66, v66, 0
    v_mul_f32 v64, v64, v67
    v_dot2_f32_bf16 v48, v16, v66, v64
    v_dot2_f32_bf16 v49, v16, v67, v64
    v_dot2_f32_bf16 v50, v17, v66, v64
    v_dot2_f32_bf16 v51, v17, v67, v64
    v_dot2_f32_bf16 v52, v18, v66, v64
    v_dot2_f32_bf16 v53, v18, v67, v64
    v_dot2_f32_bf16 v54, v19, v66, v64
    v_dot2_f32_bf16 v55, v19, v67, v64
    v_dot2_f32_bf16 v56, v20, v66, v64
    v_dot2_f32_bf16 v57, v20, v67, v64
    v_dot2_f32_bf16 v58, v21, v66, v64
    v_dot2_f32_bf16 v59, v21, v67, v64
    v_dot2_f32_bf16 v60, v22, v66, v64
    v_dot2_f32_bf16 v61, v22, v67, v64
    v_dot2_f32_bf16 v62, v23, v66, v64
    v_dot2_f32_bf16 v63, v23, v67, v64
    v_cvt_pk_bf16_f32 v16, v48, v49
    v_cvt_pk_bf16_f32 v17, v50, v51
    v_cvt_pk_bf16_f32 v18, v52, v53
    v_cvt_pk_bf16_f32 v19, v54, v55
    ds_write_b128 v68, v[16:19] offset:0
    v_dot2_f32_bf16 v48, v24, v66, v64
    v_dot2_f32_bf16 v49, v24, v67, v64
    v_dot2_f32_bf16 v50, v25, v66, v64
    v_dot2_f32_bf16 v51, v25, v67, v64
    v_dot2_f32_bf16 v52, v26, v66, v64
    v_dot2_f32_bf16 v53, v26, v67, v64
    v_dot2_f32_bf16 v54, v27, v66, v64
    v_dot2_f32_bf16 v55, v27, v67, v64
    v_cvt_pk_bf16_f32 v20, v56, v57
    v_cvt_pk_bf16_f32 v21, v58, v59
    v_cvt_pk_bf16_f32 v22, v60, v61
    v_cvt_pk_bf16_f32 v23, v62, v63
    ds_write_b128 v68, v[20:23] offset:4096
    v_dot2_f32_bf16 v56, v28, v66, v64
    v_dot2_f32_bf16 v57, v28, v67, v64
    v_dot2_f32_bf16 v58, v29, v66, v64
    v_dot2_f32_bf16 v59, v29, v67, v64
    v_dot2_f32_bf16 v60, v30, v66, v64
    v_dot2_f32_bf16 v61, v30, v67, v64
    v_dot2_f32_bf16 v62, v31, v66, v64
    v_dot2_f32_bf16 v63, v31, v67, v64
    v_cvt_pk_bf16_f32 v24, v48, v49
    v_cvt_pk_bf16_f32 v25, v50, v51
    v_cvt_pk_bf16_f32 v26, v52, v53
    v_cvt_pk_bf16_f32 v27, v54, v55
    ds_write_b128 v68, v[24:27] offset:8192
    v_dot2_f32_bf16 v48, v32, v66, v64
    v_dot2_f32_bf16 v49, v32, v67, v64
    v_dot2_f32_bf16 v50, v33, v66, v64
    v_dot2_f32_bf16 v51, v33, v67, v64
    v_dot2_f32_bf16 v52, v34, v66, v64
    v_dot2_f32_bf16 v53, v34, v67, v64
    v_dot2_f32_bf16 v54, v35, v66, v64
    v_dot2_f32_bf16 v55, v35, v67, v64
    v_cvt_pk_bf16_f32 v28, v56, v57
    v_cvt_pk_bf16_f32 v29, v58, v59
    v_cvt_pk_bf16_f32 v30, v60, v61
    v_cvt_pk_bf16_f32 v31, v62, v63
    ds_write_b128 v68, v[28:31] offset:12288
    v_xor_b32 v68, 0x4000, v68
    v_dot2_f32_bf16 v56, v36, v66, v64
    v_dot2_f32_bf16 v57, v36, v67, v64
    v_dot2_f32_bf16 v58, v37, v66, v64
    v_dot2_f32_bf16 v59, v37, v67, v64
    v_dot2_f32_bf16 v60, v38, v66, v64
    v_dot2_f32_bf16 v61, v38, v67, v64
    v_dot2_f32_bf16 v62, v39, v66, v64
    v_dot2_f32_bf16 v63, v39, v67, v64
    v_cvt_pk_bf16_f32 v32, v48, v49
    v_cvt_pk_bf16_f32 v33, v50, v51
    v_cvt_pk_bf16_f32 v34, v52, v53
    v_cvt_pk_bf16_f32 v35, v54, v55
    ds_write_b128 v68, v[32:35] offset:0
    v_dot2_f32_bf16 v48, v40, v66, v64
    v_dot2_f32_bf16 v49, v40, v67, v64
    v_dot2_f32_bf16 v50, v41, v66, v64
    v_dot2_f32_bf16 v51, v41, v67, v64
    v_dot2_f32_bf16 v52, v42, v66, v64
    v_dot2_f32_bf16 v53, v42, v67, v64
    v_dot2_f32_bf16 v54, v43, v66, v64
    v_dot2_f32_bf16 v55, v43, v67, v64
    v_cvt_pk_bf16_f32 v36, v56, v57
    v_cvt_pk_bf16_f32 v37, v58, v59
    v_cvt_pk_bf16_f32 v38, v60, v61
    v_cvt_pk_bf16_f32 v39, v62, v63
    ds_write_b128 v68, v[36:39] offset:4096
    v_dot2_f32_bf16 v56, v44, v66, v64
    v_dot2_f32_bf16 v57, v44, v67, v64
    v_dot2_f32_bf16 v58, v45, v66, v64
    v_dot2_f32_bf16 v59, v45, v67, v64
    v_dot2_f32_bf16 v60, v46, v66, v64
    v_dot2_f32_bf16 v61, v46, v67, v64
    v_dot2_f32_bf16 v62, v47, v66, v64
    v_dot2_f32_bf16 v63, v47, v67, v64
    v_cvt_pk_bf16_f32 v40, v48, v49
    v_cvt_pk_bf16_f32 v41, v50, v51
    v_cvt_pk_bf16_f32 v42, v52, v53
    v_cvt_pk_bf16_f32 v43, v54, v55
    ds_write_b128 v68, v[40:43] offset:8192
    v_cvt_pk_bf16_f32 v44, v56, v57
    v_cvt_pk_bf16_f32 v45, v58, v59
    v_cvt_pk_bf16_f32 v46, v60, v61
    v_cvt_pk_bf16_f32 v47, v62, v63
    ds_write_b128 v68, v[44:47] offset:12288
    s_mov_b64 exec, 1
    ds_add_u32 v9, v2 offset:116
    s_mov_b64 exec, -1
    s_setprio 3
    s_waitcnt vmcnt(0)
    ds_read_b64_tr_b16 v[192:193], v70 offset:0
    ds_read_b64_tr_b16 v[194:195], v70 offset:256
    ds_read_b64_tr_b16 v[196:197], v70 offset:1024
    ds_read_b64_tr_b16 v[198:199], v70 offset:1280
    ds_read_b64_tr_b16 v[200:201], v70 offset:2048
    ds_read_b64_tr_b16 v[202:203], v70 offset:2304
    ds_read_b64_tr_b16 v[204:205], v70 offset:3072
    ds_read_b64_tr_b16 v[206:207], v70 offset:3328
    ds_read_b64_tr_b16 v[208:209], v70 offset:4096
    ds_read_b64_tr_b16 v[210:211], v70 offset:4352
    ds_read_b64_tr_b16 v[212:213], v70 offset:5120
    ds_read_b64_tr_b16 v[214:215], v70 offset:5376
    ds_read_b64_tr_b16 v[216:217], v70 offset:6144
    ds_read_b64_tr_b16 v[218:219], v70 offset:6400
    ds_read_b64_tr_b16 v[220:221], v70 offset:7168
    ds_read_b64_tr_b16 v[222:223], v70 offset:7424
L_sp_1:
    ds_read_b32 v1, v9 offset:116
    s_sub_u32 s10, s10, 1
    s_cmp_lt_i32 s10, 0
    s_cbranch_scc1 L_spd_2
    s_waitcnt lgkmcnt(0)
    v_readfirstlane_b32 s9, v1
    s_cmp_lt_u32 s9, 8
    s_cbranch_scc1 L_sp_1
L_spd_2:
    ds_read_b32 v71, v9 offset:64
    ds_read_b128 v[224:227], v72 offset:0
    ds_read_b128 v[16:19], v76 offset:0
    ds_read_b128 v[228:231], v73 offset:0
    ds_read_b128 v[20:23], v77 offset:0
    s_waitcnt lgkmcnt(2)
    v_mfma_f32_32x32x16_bf16 v[128:143], v[192:195], v[224:227], 0
    ds_read_b128 v[232:235], v74 offset:0
    ds_read_b128 v[24:27], v78 offset:0
    v_mfma_f32_32x32x16_bf16 v[144:159], v[192:195], v[16:19], 0
    ds_read_b128 v[236:239], v75 offset:0
    ds_read_b128 v[28:31], v79 offset:0
    v_readfirstlane_b32 s25, v71
    s_waitcnt lgkmcnt(4)
    v_mfma_f32_32x32x16_bf16 v[128:143], v[196:199], v[228:231], v[128:143]
    ds_read_b128 v[240:243], v72 offset:4096
    ds_read_b128 v[32:35], v76 offset:4096
    v_mfma_f32_32x32x16_bf16 v[144:159], v[196:199], v[20:23], v[144:159]
    ds_read_b128 v[244:247], v73 offset:4096
    ds_read_b128 v[36:39], v77 offset:4096
    s_waitcnt lgkmcnt(6)
    v_mfma_f32_32x32x16_bf16 v[128:143], v[200:203], v[232:235], v[128:143]
    ds_read_b128 v[248:251], v74 offset:4096
    ds_read_b128 v[40:43], v78 offset:4096
    v_mfma_f32_32x32x16_bf16 v[144:159], v[200:203], v[24:27], v[144:159]
    ds_read_b128 v[252:255], v75 offset:4096
    ds_read_b128 v[44:47], v79 offset:4096
    s_waitcnt lgkmcnt(8)
    v_mfma_f32_32x32x16_bf16 v[128:143], v[204:207], v[236:239], v[128:143]
    v_mfma_f32_32x32x16_bf16 v[144:159], v[204:207], v[28:31], v[144:159]
    v_mov_b32 v64, 0
    v_mov_b32 v65, 0
    v_mov_b32 v66, 0
    v_mov_b32 v67, 0
    s_waitcnt lgkmcnt(6)
    v_mfma_f32_32x32x16_bf16 v[128:143], v[208:211], v[240:243], v[128:143]
    v_mfma_f32_32x32x16_bf16 v[144:159], v[208:211], v[32:35], v[144:159]
    ds_read_b32 v1, v81 offset:80
    ds_read_b128 v[16:19], v76 offset:8192
    s_waitcnt lgkmcnt(6)
    v_mfma_f32_32x32x16_bf16 v[128:143], v[212:215], v[244:247], v[128:143]
    ds_read_b128 v[20:23], v77 offset:8192
    ds_read_b128 v[24:27], v78 offset:8192
    v_mfma_f32_32x32x16_bf16 v[144:159], v[212:215], v[36:39], v[144:159]
    s_waitcnt lgkmcnt(6)
    v_mfma_f32_32x32x16_bf16 v[128:143], v[216:219], v[248:251], v[128:143]
    s_waitcnt lgkmcnt(3)
    v_readfirstlane_b32 s9, v1
    s_cmp_ge_u32 s9, 1
    s_cbranch_scc0 L_ckr_4
L_cko_5:
    ds_read_b64_tr_b16 v[160:161], v80 offset:0
    v_mfma_f32_32x32x16_bf16 v[144:159], v[216:219], v[40:43], v[144:159]
    ds_read_b64_tr_b16 v[162:163], v80 offset:256
    ds_read_b64_tr_b16 v[164:165], v80 offset:1024
    ds_read_b64_tr_b16 v[166:167], v80 offset:1280
    v_mfma_f32_32x32x16_bf16 v[128:143], v[220:223], v[252:255], v[128:143]
    ds_read_b64_tr_b16 v[168:169], v80 offset:2048
    ds_read_b64_tr_b16 v[170:171], v80 offset:2304
    ds_read_b128 v[28:31], v79 offset:8192
    v_mfma_f32_32x32x16_bf16 v[144:159], v[220:223], v[44:47], v[144:159]
    ds_read_b64_tr_b16 v[172:173], v80 offset:3072
    ds_read_b64_tr_b16 v[174:175], v80 offset:3328
    ds_read_b128 v[32:35], v76 offset:12288
    s_mov_b64 exec, 0xff
    buffer_load_dword v119, v107, s[64:67], s20 offen sc1
    s_mov_b64 exec, -1
    s_waitcnt lgkmcnt(8)
    v_mfma_f32_32x32x16_bf16 v[144:159], v[160:163], v[16:19], v[144:159]
    ds_read_b64_tr_b16 v[176:177], v80 offset:4096
    ds_read_b64_tr_b16 v[178:179], v80 offset:4352
    ds_read_b128 v[36:39], v77 offset:12288
    s_waitcnt lgkmcnt(9)
    v_mfma_f32_32x32x16_bf16 v[144:159], v[164:167], v[20:23], v[144:159]
    ds_read_b64_tr_b16 v[180:181], v80 offset:5120
    ds_read_b64_tr_b16 v[182:183], v80 offset:5376
    ds_read_b128 v[40:43], v78 offset:12288
    s_waitcnt lgkmcnt(10)
    v_mfma_f32_32x32x16_bf16 v[144:159], v[168:171], v[24:27], v[144:159]
    ds_read_b64_tr_b16 v[184:185], v80 offset:6144
    ds_read_b64_tr_b16 v[186:187], v80 offset:6400
    ds_read_b128 v[44:47], v79 offset:12288
    s_waitcnt lgkmcnt(10)
    v_mfma_f32_32x32x16_bf16 v[144:159], v[172:175], v[28:31], v[144:159]
    ds_read_b64_tr_b16 v[188:189], v80 offset:7168
    ds_read_b64_tr_b16 v[190:191], v80 offset:7424
    ds_read_b128 v[224:227], v72 offset:8192
    v_mov_b32 v192, 0
    v_mov_b32 v193, 0
    s_waitcnt lgkmcnt(10)
    v_mfma_f32_32x32x16_bf16 v[144:159], v[176:179], v[32:35], v[144:159]
    ds_read_b128 v[228:231], v73 offset:8192
    ds_read_b128 v[232:235], v74 offset:8192
    ds_read_b128 v[236:239], v75 offset:8192
    v_mov_b32 v194, 0
    v_mov_b32 v195, 0
    s_waitcnt lgkmcnt(10)
    v_mfma_f32_32x32x16_bf16 v[144:159], v[180:183], v[36:39], v[144:159]
    ds_read_b128 v[240:243], v72 offset:12288
    ds_read_b128 v[244:247], v73 offset:12288
    ds_read_b128 v[248:251], v74 offset:12288
    v_mov_b32 v196, 0
    v_mov_b32 v197, 0
    v_mov_b32 v198, 0
    s_waitcnt lgkmcnt(10)
    v_mfma_f32_32x32x16_bf16 v[144:159], v[184:187], v[40:43], v[144:159]
    ds_read_b128 v[252:255], v75 offset:12288
    v_mov_b32 v199, 0
    v_mov_b32 v200, 0
    s_waitcnt lgkmcnt(8)
    v_mfma_f32_32x32x16_bf16 v[144:159], v[188:191], v[44:47], v[144:159]
    v_mov_b32 v201, 0
    v_mov_b32 v202, 0
    v_mov_b32 v203, 0
    v_mov_b32 v204, 0
    v_mov_b32 v205, 0
    s_waitcnt lgkmcnt(7)
    v_mfma_f32_32x32x16_bf16 v[128:143], v[160:163], v[224:227], v[128:143]
    v_mov_b32 v206, 0
    v_mov_b32 v207, 0
    v_mov_b32 v208, 0
    v_mov_b32 v209, 0
    v_mov_b32 v210, 0
    s_waitcnt lgkmcnt(6)
    v_mfma_f32_32x32x16_bf16 v[128:143], v[164:167], v[228:231], v[128:143]
    v_mov_b32 v211, 0
    v_mov_b32 v212, 0
    v_mov_b32 v213, 0
    v_mov_b32 v214, 0
    v_mov_b32 v215, 0
    ds_write_b128 v104, v[144:147] offset:0
    s_waitcnt lgkmcnt(6)
    v_mfma_f32_32x32x16_bf16 v[128:143], v[168:171], v[232:235], v[128:143]
    ds_write_b128 v104, v[148:151] offset:1024
    s_waitcnt lgkmcnt(6)
    v_mfma_f32_32x32x16_bf16 v[128:143], v[172:175], v[236:239], v[128:143]
    ds_write_b128 v104, v[152:155] offset:2048
    s_waitcnt lgkmcnt(6)
    v_mfma_f32_32x32x16_bf16 v[128:143], v[176:179], v[240:243], v[128:143]
    s_waitcnt vmcnt(0)
    v_cmp_eq_u32 vcc, s25, v119
    s_and_b32 s9, vcc_lo, 0xff
    s_cmp_eq_u32 s9, 0xff
    s_cbranch_scc0 L_kvr_6
L_kvo_7:
    buffer_load_dwordx4 v[80:83], v8, s[64:67], s40 offen offset:0 sc1
    ds_write_b128 v104, v[156:159] offset:3072
    s_mov_b64 exec, 1
    ds_add_u32 v10, v2 offset:0
    s_mov_b64 exec, -1
    s_waitcnt lgkmcnt(7)
    v_mfma_f32_32x32x16_bf16 v[128:143], v[180:183], v[244:247], v[128:143]
    s_mov_b64 exec, s[16:17]
    buffer_load_dwordx4 v[84:87], v11, s[64:67], s40 offen offset:1024 sc1
    buffer_load_dwordx4 v[88:91], v11, s[64:67], s40 offen offset:1536 sc1
    s_mov_b64 exec, -1
    v_mov_b32 v216, 0
    v_mov_b32 v217, 0
    v_mov_b32 v218, 0
    v_mov_b32 v219, 0
    v_mov_b32 v220, 0
    s_waitcnt lgkmcnt(6)
    v_mfma_f32_32x32x16_bf16 v[128:143], v[184:187], v[248:251], v[128:143]
    buffer_load_dwordx4 v[92:95], v8, s[64:67], s40 offen offset:2048 sc1
    v_mov_b32 v221, 0
    v_mov_b32 v222, 0
    v_mov_b32 v223, 0
L_sp_8:
    ds_read_b32 v1, v10 offset:0
    s_sub_u32 s10, s10, 1
    s_cmp_lt_i32 s10, 0
    s_cbranch_scc1 L_spd_9
    s_waitcnt lgkmcnt(0)
    v_readfirstlane_b32 s9, v1
    s_cmp_lt_u32 s9, 2
    s_cbranch_scc1 L_sp_8
L_spd_9:
    v_mfma_f32_32x32x16_bf16 v[128:143], v[188:191], v[252:255], v[128:143]
    s_mov_b64 exec, s[16:17]
    buffer_load_dwordx4 v[96:99], v11, s[64:67], s40 offen offset:3072 sc1
    buffer_load_dwordx4 v[100:103], v11, s[64:67], s40 offen offset:3584 sc1
    s_mov_b64 exec, -1
    ds_read_b128 v[16:19], v105 offset:0
    ds_read_b128 v[20:23], v105 offset:1024
    ds_read_b128 v[24:27], v105 offset:2048
    ds_read_b128 v[28:31], v105 offset:3072
    buffer_load_dword v119, v107, s[64:67], s20 offen sc1
    v_mfma_f32_32x32x16_bf16 v[224:239], v[64:67], v[64:67], 0
    s_nop 5
    s_waitcnt lgkmcnt(3)
    v_add_f32 v128, v128, v16
    v_add_f32 v129, v129, v17
    v_add_f32 v130, v130, v18
    v_add_f32 v131, v131, v19
    v_cvt_pk_bf16_f32 v40, v128, v129
    v_cvt_pk_bf16_f32 v41, v130, v131
    v_mfma_f32_32x32x16_bf16 v[240:255], v[64:67], v[64:67], 0
    s_waitcnt lgkmcnt(2)
    v_add_f32 v132, v132, v20
    v_add_f32 v133, v133, v21
    v_add_f32 v134, v134, v22
    v_add_f32 v135, v135, v23
    v_cvt_pk_bf16_f32 v42, v132, v133
    v_cvt_pk_bf16_f32 v43, v134, v135
    ds_write_b128 v106, v[40:43]
    s_waitcnt vmcnt(6)
    v_mfma_f32_32x32x16_bf16 v[48:63], v[80:83], v[40:43], 0
    s_waitcnt lgkmcnt(2)
    v_add_f32 v136, v136, v24
    v_add_f32 v137, v137, v25
    v_add_f32 v138, v138, v26
    v_add_f32 v139, v139, v27
    v_cvt_pk_bf16_f32 v44, v136, v137
    v_cvt_pk_bf16_f32 v45, v138, v139
    v_mfma_f32_32x32x16_bf16 v[144:159], v[64:67], v[64:67], 0
    s_waitcnt lgkmcnt(1)
    v_add_f32 v140, v140, v28
    v_add_f32 v141, v141, v29
    v_add_f32 v142, v142, v30
    v_add_f32 v143, v143, v31
    v_cvt_pk_bf16_f32 v46, v140, v141
    v_cvt_pk_bf16_f32 v47, v142, v143
    v_mfma_f32_32x32x16_bf16 v[160:175], v[64:67], v[64:67], 0
    ds_write_b128 v106, v[44:47] offset:1024
    s_mov_b64 exec, 1
    ds_add_u32 v9, v2 offset:8
    s_mov_b64 exec, -1
    v_mfma_f32_32x32x16_bf16 v[128:143], v[64:67], v[64:67], 0
    s_setprio 1
    v_exp_f32 v48, v48
    v_exp_f32 v49, v49
    v_mfma_f32_32x32x16_bf16 v[176:191], v[64:67], v[64:67], 0
    v_exp_f32 v50, v50
    v_exp_f32 v51, v51
    v_exp_f32 v52, v52
    v_mfma_f32_32x32x16_bf16 v[64:79], v[80:83], v[44:47], 0
    v_exp_f32 v53, v53
    ds_read_b32 v10, v9 offset:8
    v_exp_f32 v54, v54
    v_exp_f32 v55, v55
    v_exp_f32 v56, v56
    v_exp_f32 v57, v57
    s_waitcnt vmcnt(4)
    v_exp_f32 v58, v58
    v_smfmac_f32_32x32x32_bf16 v[224:239], v[84:87], v[48:55], v3
    v_exp_f32 v59, v59
    s_waitcnt lgkmcnt(0)
    v_readfirstlane_b32 s9, v10
    s_cmp_ge_u32 s9, 4
    s_cbranch_scc0 L_ckr_11
L_cko_12:
    v_exp_f32 v60, v60
    ds_read_b128 v[16:19], v116 offset:0
    v_exp_f32 v61, v61
    ds_read_b128 v[20:23], v116 offset:1024
    v_exp_f32 v62, v62
    v_exp_f32 v63, v63
    v_exp_f32 v64, v64
    v_exp_f32 v65, v65
    v_smfmac_f32_32x32x32_bf16 v[224:239], v[88:91], v[56:63], v3
    v_exp_f32 v66, v66
    v_exp_f32 v67, v67
    s_waitcnt lgkmcnt(0)
    v_exp_f32 v68, v68
    v_mfma_f32_32x32x16_bf16 v[48:63], v[80:83], v[16:19], 0
    v_exp_f32 v69, v69
    ds_read_b128 v[24:27], v117 offset:0
    v_exp_f32 v70, v70
    s_waitcnt vmcnt(0)
    v_cmp_eq_u32 vcc, s25, v119
    s_cmp_eq_u64 vcc, exec
    s_cbranch_scc0 L_kvr_13
L_kvo_14:
    v_exp_f32 v71, v71
    buffer_load_dwordx4 v[104:107], v8, s[64:67], s41 offen offset:0 sc1
    v_exp_f32 v72, v72
    ds_read_b128 v[28:31], v117 offset:1024
    v_exp_f32 v73, v73
    ds_read_b128 v[32:35], v118 offset:0
    v_exp_f32 v74, v74
    v_smfmac_f32_32x32x32_bf16 v[240:255], v[84:87], v[64:71], v3
    v_exp_f32 v75, v75
    ds_read_b128 v[36:39], v118 offset:1024
    v_exp_f32 v76, v76
    v_exp_f32 v77, v77
    v_exp_f32 v78, v78
    s_mov_b64 exec, s[16:17]
    buffer_load_dwordx4 v[108:111], v11, s[64:67], s41 offen offset:1024 sc1
    buffer_load_dwordx4 v[112:115], v11, s[64:67], s41 offen offset:1536 sc1
    s_mov_b64 exec, -1
    v_exp_f32 v79, v79
    v_exp_f32 v48, v48
    v_exp_f32 v49, v49
    v_smfmac_f32_32x32x32_bf16 v[240:255], v[88:91], v[72:79], v3
    v_exp_f32 v50, v50
    v_exp_f32 v51, v51
    s_waitcnt lgkmcnt(0)
    v_exp_f32 v52, v52
    v_mfma_f32_32x32x16_bf16 v[64:79], v[80:83], v[20:23], 0
    v_exp_f32 v53, v53
    v_exp_f32 v54, v54
    buffer_load_dwordx4 v[116:119], v8, s[64:67], s41 offen offset:2048 sc1
    v_exp_f32 v55, v55
    v_exp_f32 v56, v56
    v_exp_f32 v57, v57
    v_exp_f32 v58, v58
    v_smfmac_f32_32x32x32_bf16 v[128:143], v[84:87], v[48:55], v3
    v_exp_f32 v59, v59
    v_exp_f32 v60, v60
    s_mov_b64 exec, s[16:17]
    buffer_load_dwordx4 v[120:123], v11, s[64:67], s41 offen offset:3072 sc1
    buffer_load_dwordx4 v[124:127], v11, s[64:67], s41 offen offset:3584 sc1
    s_mov_b64 exec, -1
    v_exp_f32 v61, v61
    v_exp_f32 v62, v62
    s_mov_b64 exec, 1
    ds_add_u32 v9, v2 offset:96
    s_mov_b64 exec, -1
    v_exp_f32 v63, v63
    v_exp_f32 v64, v64
    v_exp_f32 v65, v65
    v_smfmac_f32_32x32x32_bf16 v[128:143], v[88:91], v[56:63], v3
    v_exp_f32 v66, v66
    v_exp_f32 v67, v67
    v_exp_f32 v68, v68
    v_mfma_f32_32x32x16_bf16 v[48:63], v[80:83], v[24:27], 0
    v_exp_f32 v69, v69
    v_exp_f32 v70, v70
    v_exp_f32 v71, v71
    v_exp_f32 v72, v72
    v_exp_f32 v73, v73
    v_exp_f32 v74, v74
    v_smfmac_f32_32x32x32_bf16 v[144:159], v[84:87], v[64:71], v3
    v_exp_f32 v75, v75
    v_exp_f32 v76, v76
    v_exp_f32 v77, v77
    v_exp_f32 v78, v78
    v_exp_f32 v79, v79
    v_exp_f32 v48, v48
    v_exp_f32 v49, v49
    v_smfmac_f32_32x32x32_bf16 v[144:159], v[88:91], v[72:79], v3
    v_exp_f32 v50, v50
    v_exp_f32 v51, v51
    v_exp_f32 v52, v52
    v_mfma_f32_32x32x16_bf16 v[64:79], v[80:83], v[28:31], 0
    v_exp_f32 v53, v53
    v_exp_f32 v54, v54
    v_exp_f32 v55, v55
    v_exp_f32 v56, v56
    v_exp_f32 v57, v57
    v_exp_f32 v58, v58
    v_smfmac_f32_32x32x32_bf16 v[160:175], v[84:87], v[48:55], v3
    v_exp_f32 v59, v59
    v_exp_f32 v60, v60
    v_exp_f32 v61, v61
    v_exp_f32 v62, v62
    v_exp_f32 v63, v63
    v_exp_f32 v64, v64
    v_exp_f32 v65, v65
    v_smfmac_f32_32x32x32_bf16 v[160:175], v[88:91], v[56:63], v3
    v_exp_f32 v66, v66
    v_exp_f32 v67, v67
    v_exp_f32 v68, v68
    v_mfma_f32_32x32x16_bf16 v[48:63], v[80:83], v[32:35], 0
    v_exp_f32 v69, v69
    v_exp_f32 v70, v70
    v_exp_f32 v71, v71
    v_exp_f32 v72, v72
    v_exp_f32 v73, v73
    v_exp_f32 v74, v74
    v_smfmac_f32_32x32x32_bf16 v[176:191], v[84:87], v[64:71], v3
    v_exp_f32 v75, v75
    v_exp_f32 v76, v76
    v_exp_f32 v77, v77
    v_exp_f32 v78, v78
    v_exp_f32 v79, v79
    v_exp_f32 v48, v48
    v_exp_f32 v49, v49
    v_smfmac_f32_32x32x32_bf16 v[176:191], v[88:91], v[72:79], v3
    v_exp_f32 v50, v50
    v_exp_f32 v51, v51
    v_exp_f32 v52, v52
    v_mfma_f32_32x32x16_bf16 v[64:79], v[80:83], v[36:39], 0
    v_exp_f32 v53, v53
    v_exp_f32 v54, v54
    v_exp_f32 v55, v55
    v_exp_f32 v56, v56
    v_exp_f32 v57, v57
    v_exp_f32 v58, v58
    v_smfmac_f32_32x32x32_bf16 v[192:207], v[84:87], v[48:55], v3
    v_exp_f32 v59, v59
    v_exp_f32 v60, v60
    v_exp_f32 v61, v61
    v_exp_f32 v62, v62
    v_exp_f32 v63, v63
    v_exp_f32 v64, v64
    v_exp_f32 v65, v65
    v_smfmac_f32_32x32x32_bf16 v[192:207], v[88:91], v[56:63], v3
    v_exp_f32 v66, v66
    v_exp_f32 v67, v67
    v_exp_f32 v68, v68
    v_mfma_f32_32x32x16_bf16 v[48:63], v[92:95], v[16:19], 0
    v_exp_f32 v69, v69
    v_exp_f32 v70, v70
    v_exp_f32 v71, v71
    v_exp_f32 v72, v72
    v_exp_f32 v73, v73
    v_exp_f32 v74, v74
    v_smfmac_f32_32x32x32_bf16 v[208:223], v[84:87], v[64:71], v3
    v_exp_f32 v75, v75
    v_exp_f32 v76, v76
    v_exp_f32 v77, v77
    v_exp_f32 v78, v78
    v_exp_f32 v79, v79
    v_exp_f32 v48, v48
    v_exp_f32 v49, v49
    v_smfmac_f32_32x32x32_bf16 v[208:223], v[88:91], v[72:79], v3
    v_exp_f32 v50, v50
    v_exp_f32 v51, v51
    v_exp_f32 v52, v52
    v_mfma_f32_32x32x16_bf16 v[64:79], v[92:95], v[20:23], 0
    v_exp_f32 v53, v53
    v_exp_f32 v54, v54
    v_exp_f32 v55, v55
    v_exp_f32 v56, v56
    v_exp_f32 v57, v57
    v_exp_f32 v58, v58
    v_smfmac_f32_32x32x32_bf16 v[128:143], v[96:99], v[48:55], v3
    v_exp_f32 v59, v59
    v_exp_f32 v60, v60
    v_exp_f32 v61, v61
    v_exp_f32 v62, v62
    v_exp_f32 v63, v63
    v_exp_f32 v64, v64
    v_exp_f32 v65, v65
    v_smfmac_f32_32x32x32_bf16 v[128:143], v[100:103], v[56:63], v3
    v_exp_f32 v66, v66
    v_exp_f32 v67, v67
    v_exp_f32 v68, v68
    v_mfma_f32_32x32x16_bf16 v[48:63], v[92:95], v[24:27], 0
    v_exp_f32 v69, v69
    v_exp_f32 v70, v70
    buffer_load_dwordx4 v[80:83], v8, s[64:67], s42 offen offset:0 sc1
    v_exp_f32 v71, v71
L_pga1:
    s_cbranch_execz L_rta1
    v_exp_f32 v72, v72
    v_exp_f32 v73, v73
    v_exp_f32 v74, v74
    v_smfmac_f32_32x32x32_bf16 v[144:159], v[96:99], v[64:71], v3
    v_exp_f32 v75, v75
    v_exp_f32 v76, v76
    s_mov_b64 exec, s[16:17]
    buffer_load_dwordx4 v[84:87], v11, s[64:67], s42 offen offset:1024 sc1
    buffer_load_dwordx4 v[88:91], v11, s[64:67], s42 offen offset:1536 sc1
    s_mov_b64 exec, -1
    v_exp_f32 v77, v77
    v_exp_f32 v78, v78
    v_exp_f32 v79, v79
    v_exp_f32 v48, v48
    v_exp_f32 v49, v49
    v_smfmac_f32_32x32x32_bf16 v[144:159], v[100:103], v[72:79], v3
    v_exp_f32 v50, v50
    v_exp_f32 v51, v51
    v_exp_f32 v52, v52
    v_mfma_f32_32x32x16_bf16 v[64:79], v[92:95], v[28:31], 0
    v_exp_f32 v53, v53
    v_exp_f32 v54, v54
    v_exp_f32 v55, v55
    v_exp_f32 v56, v56
    v_exp_f32 v57, v57
    v_exp_f32 v58, v58
    v_smfmac_f32_32x32x32_bf16 v[160:175], v[96:99], v[48:55], v3
    v_exp_f32 v59, v59
    v_exp_f32 v60, v60
    v_exp_f32 v61, v61
    v_exp_f32 v62, v62
    v_exp_f32 v63, v63
    v_exp_f32 v64, v64
    v_exp_f32 v65, v65
    v_smfmac_f32_32x32x32_bf16 v[160:175], v[100:103], v[56:63], v3
    v_exp_f32 v66, v66
    v_exp_f32 v67, v67
    v_exp_f32 v68, v68
    v_mfma_f32_32x32x16_bf16 v[48:63], v[92:95], v[32:35], 0
    v_exp_f32 v69, v69
    v_exp_f32 v70, v70
    v_exp_f32 v71, v71
    v_exp_f32 v72, v72
    v_exp_f32 v73, v73
    v_exp_f32 v74, v74
    v_smfmac_f32_32x32x32_bf16 v[176:191], v[96:99], v[64:71], v3
    v_exp_f32 v75, v75
    v_exp_f32 v76, v76
    v_exp_f32 v77, v77
    v_exp_f32 v78, v78
    v_exp_f32 v79, v79
    v_exp_f32 v48, v48
    v_exp_f32 v49, v49
    v_smfmac_f32_32x32x32_bf16 v[176:191], v[100:103], v[72:79], v3
    v_exp_f32 v50, v50
    v_exp_f32 v51, v51
    v_exp_f32 v52, v52
    v_mfma_f32_32x32x16_bf16 v[64:79], v[92:95], v[36:39], 0
    v_exp_f32 v53, v53
    v_exp_f32 v54, v54
    v_exp_f32 v55, v55
    v_exp_f32 v56, v56
    v_exp_f32 v57, v57
    v_exp_f32 v58, v58
    v_smfmac_f32_32x32x32_bf16 v[192:207], v[96:99], v[48:55], v3
    v_exp_f32 v59, v59
    v_exp_f32 v60, v60
    v_exp_f32 v61, v61
    v_exp_f32 v62, v62
    v_exp_f32 v63, v63
    v_exp_f32 v64, v64
    v_exp_f32 v65, v65
    v_smfmac_f32_32x32x32_bf16 v[192:207], v[100:103], v[56:63], v3
    v_exp_f32 v66, v66
    v_exp_f32 v67, v67
    v_exp_f32 v68, v68
    v_mfma_f32_32x32x16_bf16 v[48:63], v[92:95], v[40:43], 0
    v_exp_f32 v69, v69
    v_exp_f32 v70, v70
    v_exp_f32 v71, v71
    v_exp_f32 v72, v72
    v_exp_f32 v73, v73
    v_exp_f32 v74, v74
    v_smfmac_f32_32x32x32_bf16 v[208:223], v[96:99], v[64:71], v3
    v_exp_f32 v75, v75
    v_exp_f32 v76, v76
    v_exp_f32 v77, v77
    v_exp_f32 v78, v78
    v_exp_f32 v79, v79
    v_exp_f32 v48, v48
    v_exp_f32 v49, v49
    v_smfmac_f32_32x32x32_bf16 v[208:223], v[100:103], v[72:79], v3
    v_exp_f32 v50, v50
    v_exp_f32 v51, v51
    v_exp_f32 v52, v52
    v_mfma_f32_32x32x16_bf16 v[64:79], v[92:95], v[44:47], 0
    v_exp_f32 v53, v53
    v_exp_f32 v54, v54
    v_exp_f32 v55, v55
    v_exp_f32 v56, v56
    v_exp_f32 v57, v57
    v_exp_f32 v58, v58
    v_smfmac_f32_32x32x32_bf16 v[224:239], v[96:99], v[48:55], v3
    v_exp_f32 v59, v59
    v_exp_f32 v60, v60
    v_exp_f32 v61, v61
    v_exp_f32 v62, v62
    v_exp_f32 v63, v63
    v_exp_f32 v64, v64
    v_exp_f32 v65, v65
    v_smfmac_f32_32x32x32_bf16 v[224:239], v[100:103], v[56:63], v3
    v_exp_f32 v66, v66
    v_exp_f32 v67, v67
    s_waitcnt vmcnt(6)
    v_exp_f32 v68, v68
    v_mfma_f32_32x32x16_bf16 v[48:63], v[104:107], v[16:19], 0
    v_exp_f32 v69, v69
    v_exp_f32 v70, v70
    v_exp_f32 v71, v71
    v_exp_f32 v72, v72
    v_exp_f32 v73, v73
    v_exp_f32 v74, v74
    v_smfmac_f32_32x32x32_bf16 v[240:255], v[96:99], v[64:71], v3
    v_exp_f32 v75, v75
    v_exp_f32 v76, v76
    v_exp_f32 v77, v77
    v_exp_f32 v78, v78
    v_exp_f32 v79, v79
    v_exp_f32 v48, v48
    v_exp_f32 v49, v49
    v_smfmac_f32_32x32x32_bf16 v[240:255], v[100:103], v[72:79], v3
    v_exp_f32 v50, v50
    v_exp_f32 v51, v51
    v_exp_f32 v52, v52
    v_mfma_f32_32x32x16_bf16 v[64:79], v[104:107], v[20:23], 0
    v_exp_f32 v53, v53
    v_exp_f32 v54, v54
    v_exp_f32 v55, v55
    v_exp_f32 v56, v56
    v_exp_f32 v57, v57
    v_exp_f32 v58, v58
    v_smfmac_f32_32x32x32_bf16 v[128:143], v[108:111], v[48:55], v3
    v_exp_f32 v59, v59
    v_exp_f32 v60, v60
    v_exp_f32 v61, v61
    v_exp_f32 v62, v62
    v_exp_f32 v63, v63
    v_exp_f32 v64, v64
    v_exp_f32 v65, v65
    v_smfmac_f32_32x32x32_bf16 v[128:143], v[112:115], v[56:63], v3
    v_exp_f32 v66, v66
    v_exp_f32 v67, v67
    v_exp_f32 v68, v68
    v_mfma_f32_32x32x16_bf16 v[48:63], v[104:107], v[24:27], 0
    v_exp_f32 v69, v69
    v_exp_f32 v70, v70
    buffer_load_dwordx4 v[92:95], v8, s[64:67], s42 offen offset:2048 sc1
    v_exp_f32 v71, v71
    v_exp_f32 v72, v72
    v_exp_f32 v73, v73
    v_exp_f32 v74, v74
    v_smfmac_f32_32x32x32_bf16 v[144:159], v[108:111], v[64:71], v3
    v_exp_f32 v75, v75
    v_exp_f32 v76, v76
    s_mov_b64 exec, s[16:17]
    buffer_load_dwordx4 v[96:99], v11, s[64:67], s42 offen offset:3072 sc1
    buffer_load_dwordx4 v[100:103], v11, s[64:67], s42 offen offset:3584 sc1
    s_mov_b64 exec, -1
    v_exp_f32 v77, v77
    v_exp_f32 v78, v78
    v_exp_f32 v79, v79
    v_exp_f32 v48, v48
    v_exp_f32 v49, v49
    v_smfmac_f32_32x32x32_bf16 v[144:159], v[112:115], v[72:79], v3
    v_exp_f32 v50, v50
    v_exp_f32 v51, v51
    v_exp_f32 v52, v52
    v_mfma_f32_32x32x16_bf16 v[64:79], v[104:107], v[28:31], 0
    v_exp_f32 v53, v53
    v_exp_f32 v54, v54
    v_exp_f32 v55, v55
    v_exp_f32 v56, v56
    v_exp_f32 v57, v57
    v_exp_f32 v58, v58
    v_smfmac_f32_32x32x32_bf16 v[160:175], v[108:111], v[48:55], v3
    v_exp_f32 v59, v59
    v_exp_f32 v60, v60
    v_exp_f32 v61, v61
    v_exp_f32 v62, v62
    v_exp_f32 v63, v63
    v_exp_f32 v64, v64
    v_exp_f32 v65, v65
    v_smfmac_f32_32x32x32_bf16 v[160:175], v[112:115], v[56:63], v3
    v_exp_f32 v66, v66
    v_exp_f32 v67, v67
    v_exp_f32 v68, v68
    v_mfma_f32_32x32x16_bf16 v[48:63], v[104:107], v[32:35], 0
    v_exp_f32 v69, v69
    v_exp_f32 v70, v70
    v_exp_f32 v71, v71
    v_exp_f32 v72, v72
    v_exp_f32 v73, v73
    v_exp_f32 v74, v74
    v_smfmac_f32_32x32x32_bf16 v[176:191], v[108:111], v[64:71], v3
    v_exp_f32 v75, v75
    v_exp_f32 v76, v76
    v_exp_f32 v77, v77
    v_exp_f32 v78, v78
    v_exp_f32 v79, v79
    v_exp_f32 v48, v48
    v_exp_f32 v49, v49
    v_smfmac_f32_32x32x32_bf16 v[176:191], v[112:115], v[72:79], v3
    v_exp_f32 v50, v50
    v_exp_f32 v51, v51
    v_exp_f32 v52, v52
    v_mfma_f32_32x32x16_bf16 v[64:79], v[104:107], v[36:39], 0
    v_exp_f32 v53, v53
    v_exp_f32 v54, v54
    v_exp_f32 v55, v55
    v_exp_f32 v56, v56
    v_exp_f32 v57, v57
    v_exp_f32 v58, v58
    v_smfmac_f32_32x32x32_bf16 v[192:207], v[108:111], v[48:55], v3
    v_exp_f32 v59, v59
    v_exp_f32 v60, v60
    v_exp_f32 v61, v61
    v_exp_f32 v62, v62
    v_exp_f32 v63, v63
    v_exp_f32 v64, v64
    v_exp_f32 v65, v65
    v_smfmac_f32_32x32x32_bf16 v[192:207], v[112:115], v[56:63], v3
    v_exp_f32 v66, v66
    v_exp_f32 v67, v67
    v_exp_f32 v68, v68
    v_mfma_f32_32x32x16_bf16 v[48:63], v[104:107], v[40:43], 0
    v_exp_f32 v69, v69
    v_exp_f32 v70, v70
    v_exp_f32 v71, v71
    v_exp_f32 v72, v72
    v_exp_f32 v73, v73
    v_exp_f32 v74, v74
    v_smfmac_f32_32x32x32_bf16 v[208:223], v[108:111], v[64:71], v3
    v_exp_f32 v75, v75
    v_exp_f32 v76, v76
    v_exp_f32 v77, v77
    v_exp_f32 v78, v78
    v_exp_f32 v79, v79
    v_exp_f32 v48, v48
    v_exp_f32 v49, v49
    v_smfmac_f32_32x32x32_bf16 v[208:223], v[112:115], v[72:79], v3
    v_exp_f32 v50, v50
    v_exp_f32 v51, v51
    v_exp_f32 v52, v52
    v_mfma_f32_32x32x16_bf16 v[64:79], v[104:107], v[44:47], 0
    v_exp_f32 v53, v53
    v_exp_f32 v54, v54
    v_exp_f32 v55, v55
    v_exp_f32 v56, v56
    v_exp_f32 v57, v57
    v_exp_f32 v58, v58
    v_smfmac_f32_32x32x32_bf16 v[224:239], v[108:111], v[48:55], v3
    v_exp_f32 v59, v59
    v_exp_f32 v60, v60
    v_exp_f32 v61, v61
    v_exp_f32 v62, v62
    v_exp_f32 v63, v63
    v_exp_f32 v64, v64
    v_exp_f32 v65, v65
    v_smfmac_f32_32x32x32_bf16 v[224:239], v[112:115], v[56:63], v3
    v_exp_f32 v66, v66
    v_exp_f32 v67, v67
    s_waitcnt vmcnt(6)
    v_exp_f32 v68, v68
    v_mfma_f32_32x32x16_bf16 v[48:63], v[116:119], v[16:19], 0
    v_exp_f32 v69, v69
    v_exp_f32 v70, v70
    v_exp_f32 v71, v71
    v_exp_f32 v72, v72
    v_exp_f32 v73, v73
    v_exp_f32 v74, v74
    v_smfmac_f32_32x32x32_bf16 v[240:255], v[108:111], v[64:71], v3
    v_exp_f32 v75, v75
    v_exp_f32 v76, v76
    v_exp_f32 v77, v77
    v_exp_f32 v78, v78
    v_exp_f32 v79, v79
    v_exp_f32 v48, v48
    v_exp_f32 v49, v49
    v_smfmac_f32_32x32x32_bf16 v[240:255], v[112:115], v[72:79], v3
    v_exp_f32 v50, v50
    v_exp_f32 v51, v51
    v_exp_f32 v52, v52
    v_mfma_f32_32x32x16_bf16 v[64:79], v[116:119], v[20:23], 0
    v_exp_f32 v53, v53
    v_exp_f32 v54, v54
    v_exp_f32 v55, v55
    v_exp_f32 v56, v56
    v_exp_f32 v57, v57
    v_exp_f32 v58, v58
    v_smfmac_f32_32x32x32_bf16 v[128:143], v[120:123], v[48:55], v3
    v_exp_f32 v59, v59
    v_exp_f32 v60, v60
    v_exp_f32 v61, v61
    v_exp_f32 v62, v62
    v_exp_f32 v63, v63
    v_exp_f32 v64, v64
    v_exp_f32 v65, v65
    v_smfmac_f32_32x32x32_bf16 v[128:143], v[124:127], v[56:63], v3
    v_exp_f32 v66, v66
    v_exp_f32 v67, v67
    v_exp_f32 v68, v68
    v_mfma_f32_32x32x16_bf16 v[48:63], v[116:119], v[24:27], 0
    v_exp_f32 v69, v69
    v_exp_f32 v70, v70
    buffer_load_dwordx4 v[104:107], v8, s[64:67], s43 offen offset:0 sc1
    v_exp_f32 v71, v71
    v_exp_f32 v72, v72
    v_exp_f32 v73, v73
    v_exp_f32 v74, v74
    v_smfmac_f32_32x32x32_bf16 v[144:159], v[120:123], v[64:71], v3
    v_exp_f32 v75, v75
    v_exp_f32 v76, v76
    s_mov_b64 exec, s[16:17]
    buffer_load_dwordx4 v[108:111], v11, s[64:67], s43 offen offset:1024 sc1
    buffer_load_dwordx4 v[112:115], v11, s[64:67], s43 offen offset:1536 sc1
    s_mov_b64 exec, -1
    v_exp_f32 v77, v77
    v_exp_f32 v78, v78
    v_exp_f32 v79, v79
    v_exp_f32 v48, v48
    v_exp_f32 v49, v49
    v_smfmac_f32_32x32x32_bf16 v[144:159], v[124:127], v[72:79], v3
    v_exp_f32 v50, v50
    v_exp_f32 v51, v51
    v_exp_f32 v52, v52
    v_mfma_f32_32x32x16_bf16 v[64:79], v[116:119], v[28:31], 0
    v_exp_f32 v53, v53
    v_exp_f32 v54, v54
    v_exp_f32 v55, v55
    v_exp_f32 v56, v56
    v_exp_f32 v57, v57
    v_exp_f32 v58, v58
    v_smfmac_f32_32x32x32_bf16 v[160:175], v[120:123], v[48:55], v3
    v_exp_f32 v59, v59
    v_exp_f32 v60, v60
    v_exp_f32 v61, v61
    v_exp_f32 v62, v62
    v_exp_f32 v63, v63
    v_exp_f32 v64, v64
    v_exp_f32 v65, v65
    v_smfmac_f32_32x32x32_bf16 v[160:175], v[124:127], v[56:63], v3
    v_exp_f32 v66, v66
    v_exp_f32 v67, v67
    v_exp_f32 v68, v68
    v_mfma_f32_32x32x16_bf16 v[48:63], v[116:119], v[32:35], 0
    v_exp_f32 v69, v69
    v_exp_f32 v70, v70
    v_exp_f32 v71, v71
    v_exp_f32 v72, v72
    v_exp_f32 v73, v73
    v_exp_f32 v74, v74
    v_smfmac_f32_32x32x32_bf16 v[176:191], v[120:123], v[64:71], v3
    v_exp_f32 v75, v75
    v_exp_f32 v76, v76
    v_exp_f32 v77, v77
    v_exp_f32 v78, v78
    v_exp_f32 v79, v79
    v_exp_f32 v48, v48
    v_exp_f32 v49, v49
    v_smfmac_f32_32x32x32_bf16 v[176:191], v[124:127], v[72:79], v3
    v_exp_f32 v50, v50
    v_exp_f32 v51, v51
    v_exp_f32 v52, v52
    v_mfma_f32_32x32x16_bf16 v[64:79], v[116:119], v[36:39], 0
    v_exp_f32 v53, v53
    v_exp_f32 v54, v54
    v_exp_f32 v55, v55
    v_exp_f32 v56, v56
    v_exp_f32 v57, v57
    v_exp_f32 v58, v58
    v_smfmac_f32_32x32x32_bf16 v[192:207], v[120:123], v[48:55], v3
    v_exp_f32 v59, v59
    v_exp_f32 v60, v60
    v_exp_f32 v61, v61
    v_exp_f32 v62, v62
    v_exp_f32 v63, v63
    v_exp_f32 v64, v64
    v_exp_f32 v65, v65
    v_smfmac_f32_32x32x32_bf16 v[192:207], v[124:127], v[56:63], v3
    v_exp_f32 v66, v66
    v_exp_f32 v67, v67
    v_exp_f32 v68, v68
    v_mfma_f32_32x32x16_bf16 v[48:63], v[116:119], v[40:43], 0
    v_exp_f32 v69, v69
    v_exp_f32 v70, v70
    v_exp_f32 v71, v71
    v_exp_f32 v72, v72
    v_exp_f32 v73, v73
    v_exp_f32 v74, v74
    v_smfmac_f32_32x32x32_bf16 v[208:223], v[120:123], v[64:71], v3
    v_exp_f32 v75, v75
    v_exp_f32 v76, v76
    v_exp_f32 v77, v77
    v_exp_f32 v78, v78
    v_exp_f32 v79, v79
    v_exp_f32 v48, v48
    v_exp_f32 v49, v49
    v_smfmac_f32_32x32x32_bf16 v[208:223], v[124:127], v[72:79], v3
    v_exp_f32 v50, v50
    v_exp_f32 v51, v51
    v_exp_f32 v52, v52
    v_mfma_f32_32x32x16_bf16 v[64:79], v[116:119], v[44:47], 0
    v_exp_f32 v53, v53
    v_exp_f32 v54, v54
    v_exp_f32 v55, v55
    v_exp_f32 v56, v56
    v_exp_f32 v57, v57
    v_exp_f32 v58, v58
    v_smfmac_f32_32x32x32_bf16 v[224:239], v[120:123], v[48:55], v3
    v_exp_f32 v59, v59
    v_exp_f32 v60, v60
    v_exp_f32 v61, v61
    v_exp_f32 v62, v62
    v_exp_f32 v63, v63
    v_exp_f32 v64, v64
    v_exp_f32 v65, v65
    v_smfmac_f32_32x32x32_bf16 v[224:239], v[124:127], v[56:63], v3
    v_exp_f32 v66, v66
    v_exp_f32 v67, v67
    s_waitcnt vmcnt(6)
    v_exp_f32 v68, v68
    v_mfma_f32_32x32x16_bf16 v[48:63], v[80:83], v[16:19], 0
    v_exp_f32 v69, v69
    v_exp_f32 v70, v70
    v_exp_f32 v71, v71
    v_exp_f32 v72, v72
    v_exp_f32 v73, v73
    v_exp_f32 v74, v74
    v_smfmac_f32_32x32x32_bf16 v[240:255], v[120:123], v[64:71], v3
    v_exp_f32 v75, v75
    v_exp_f32 v76, v76
    v_exp_f32 v77, v77
    v_exp_f32 v78, v78
    v_exp_f32 v79, v79
    v_exp_f32 v48, v48
    v_exp_f32 v49, v49
    v_smfmac_f32_32x32x32_bf16 v[240:255], v[124:127], v[72:79], v3
    v_exp_f32 v50, v50
    v_exp_f32 v51, v51
    v_exp_f32 v52, v52
    v_mfma_f32_32x32x16_bf16 v[64:79], v[80:83], v[20:23], 0
    v_exp_f32 v53, v53
    v_exp_f32 v54, v54
    v_exp_f32 v55, v55
    v_exp_f32 v56, v56
    v_exp_f32 v57, v57
    v_exp_f32 v58, v58
    v_smfmac_f32_32x32x32_bf16 v[128:143], v[84:87], v[48:55], v3
    v_exp_f32 v59, v59
    v_exp_f32 v60, v60
    v_exp_f32 v61, v61
    v_exp_f32 v62, v62
    v_exp_f32 v63, v63
    v_exp_f32 v64, v64
    v_exp_f32 v65, v65
    v_smfmac_f32_32x32x32_bf16 v[128:143], v[88:91], v[56:63], v3
    v_exp_f32 v66, v66
    v_exp_f32 v67, v67
    v_exp_f32 v68, v68
    v_mfma_f32_32x32x16_bf16 v[48:63], v[80:83], v[24:27], 0
    v_exp_f32 v69, v69
    v_exp_f32 v70, v70
    buffer_load_dwordx4 v[116:119], v8, s[64:67], s43 offen offset:2048 sc1
    v_exp_f32 v71, v71
    v_exp_f32 v72, v72
    v_exp_f32 v73, v73
    v_exp_f32 v74, v74
    v_smfmac_f32_32x32x32_bf16 v[144:159], v[84:87], v[64:71], v3
    v_exp_f32 v75, v75
    v_exp_f32 v76, v76
    s_mov_b64 exec, s[16:17]
    buffer_load_dwordx4 v[120:123], v11, s[64:67], s43 offen offset:3072 sc1
    buffer_load_dwordx4 v[124:127], v11, s[64:67], s43 offen offset:3584 sc1
    s_mov_b64 exec, -1
    v_exp_f32 v77, v77
    v_exp_f32 v78, v78
    v_exp_f32 v79, v79
    v_exp_f32 v48, v48
    v_exp_f32 v49, v49
    v_smfmac_f32_32x32x32_bf16 v[144:159], v[88:91], v[72:79], v3
    v_exp_f32 v50, v50
    v_exp_f32 v51, v51
    v_exp_f32 v52, v52
    v_mfma_f32_32x32x16_bf16 v[64:79], v[80:83], v[28:31], 0
    v_exp_f32 v53, v53
    v_exp_f32 v54, v54
    v_exp_f32 v55, v55
    v_exp_f32 v56, v56
    v_exp_f32 v57, v57
    v_exp_f32 v58, v58
    v_smfmac_f32_32x32x32_bf16 v[160:175], v[84:87], v[48:55], v3
    v_exp_f32 v59, v59
    v_exp_f32 v60, v60
    v_exp_f32 v61, v61
    v_exp_f32 v62, v62
    v_exp_f32 v63, v63
    v_exp_f32 v64, v64
    v_exp_f32 v65, v65
    v_smfmac_f32_32x32x32_bf16 v[160:175], v[88:91], v[56:63], v3
    v_exp_f32 v66, v66
    v_exp_f32 v67, v67
    v_exp_f32 v68, v68
    v_mfma_f32_32x32x16_bf16 v[48:63], v[80:83], v[32:35], 0
    v_exp_f32 v69, v69
    v_exp_f32 v70, v70
    v_exp_f32 v71, v71
    v_exp_f32 v72, v72
    v_exp_f32 v73, v73
    v_exp_f32 v74, v74
    v_smfmac_f32_32x32x32_bf16 v[176:191], v[84:87], v[64:71], v3
    v_exp_f32 v75, v75
    v_exp_f32 v76, v76
    v_exp_f32 v77, v77
    v_exp_f32 v78, v78
    v_exp_f32 v79, v79
    v_exp_f32 v48, v48
    v_exp_f32 v49, v49
    v_smfmac_f32_32x32x32_bf16 v[176:191], v[88:91], v[72:79], v3
    v_exp_f32 v50, v50
    v_exp_f32 v51, v51
    v_exp_f32 v52, v52
    v_mfma_f32_32x32x16_bf16 v[64:79], v[80:83], v[36:39], 0
    v_exp_f32 v53, v53
    v_exp_f32 v54, v54
    v_exp_f32 v55, v55
    v_exp_f32 v56, v56
    v_exp_f32 v57, v57
    v_exp_f32 v58, v58
    v_smfmac_f32_32x32x32_bf16 v[192:207], v[84:87], v[48:55], v3
    v_exp_f32 v59, v59
    v_exp_f32 v60, v60
    v_exp_f32 v61, v61
    v_exp_f32 v62, v62
    v_exp_f32 v63, v63
    v_exp_f32 v64, v64
    v_exp_f32 v65, v65
    v_smfmac_f32_32x32x32_bf16 v[192:207], v[88:91], v[56:63], v3
    v_exp_f32 v66, v66
    v_exp_f32 v67, v67
    v_exp_f32 v68, v68
    v_mfma_f32_32x32x16_bf16 v[48:63], v[80:83], v[40:43], 0
    v_exp_f32 v69, v69
    v_exp_f32 v70, v70
    v_exp_f32 v71, v71
    v_exp_f32 v72, v72
    v_exp_f32 v73, v73
    v_exp_f32 v74, v74
    v_smfmac_f32_32x32x32_bf16 v[208:223], v[84:87], v[64:71], v3
    v_exp_f32 v75, v75
    v_exp_f32 v76, v76
    v_exp_f32 v77, v77
    v_exp_f32 v78, v78
    v_exp_f32 v79, v79
    v_exp_f32 v48, v48
    v_exp_f32 v49, v49
    v_smfmac_f32_32x32x32_bf16 v[208:223], v[88:91], v[72:79], v3
    v_exp_f32 v50, v50
    v_exp_f32 v51, v51
    v_exp_f32 v52, v52
    v_mfma_f32_32x32x16_bf16 v[64:79], v[80:83], v[44:47], 0
    v_exp_f32 v53, v53
    v_exp_f32 v54, v54
    v_exp_f32 v55, v55
    v_exp_f32 v56, v56
    v_exp_f32 v57, v57
    v_exp_f32 v58, v58
    v_smfmac_f32_32x32x32_bf16 v[224:239], v[84:87], v[48:55], v3
    v_exp_f32 v59, v59
    v_exp_f32 v60, v60
    v_exp_f32 v61, v61
    v_exp_f32 v62, v62
    v_exp_f32 v63, v63
    v_exp_f32 v64, v64
    v_exp_f32 v65, v65
    v_smfmac_f32_32x32x32_bf16 v[224:239], v[88:91], v[56:63], v3
    v_exp_f32 v66, v66
    v_exp_f32 v67, v67
    s_waitcnt vmcnt(6)
    v_exp_f32 v68, v68
    v_mfma_f32_32x32x16_bf16 v[48:63], v[92:95], v[16:19], 0
    v_exp_f32 v69, v69
    v_exp_f32 v70, v70
    v_exp_f32 v71, v71
    v_exp_f32 v72, v72
    v_exp_f32 v73, v73
    v_exp_f32 v74, v74
    v_smfmac_f32_32x32x32_bf16 v[240:255], v[84:87], v[64:71], v3
    v_exp_f32 v75, v75
    v_exp_f32 v76, v76
    v_exp_f32 v77, v77
    v_exp_f32 v78, v78
    v_exp_f32 v79, v79
    v_exp_f32 v48, v48
    v_exp_f32 v49, v49
    v_smfmac_f32_32x32x32_bf16 v[240:255], v[88:91], v[72:79], v3
    v_exp_f32 v50, v50
    v_exp_f32 v51, v51
    v_exp_f32 v52, v52
    v_mfma_f32_32x32x16_bf16 v[64:79], v[92:95], v[20:23], 0
    v_exp_f32 v53, v53
    v_exp_f32 v54, v54
    v_exp_f32 v55, v55
    v_exp_f32 v56, v56
    v_exp_f32 v57, v57
    v_exp_f32 v58, v58
    v_smfmac_f32_32x32x32_bf16 v[128:143], v[96:99], v[48:55], v3
    v_exp_f32 v59, v59
    v_exp_f32 v60, v60
    v_exp_f32 v61, v61
    v_exp_f32 v62, v62
    v_exp_f32 v63, v63
    v_exp_f32 v64, v64
    v_exp_f32 v65, v65
    v_smfmac_f32_32x32x32_bf16 v[128:143], v[100:103], v[56:63], v3
    v_exp_f32 v66, v66
    v_exp_f32 v67, v67
    v_exp_f32 v68, v68
    v_mfma_f32_32x32x16_bf16 v[48:63], v[92:95], v[24:27], 0
    v_exp_f32 v69, v69
    v_exp_f32 v70, v70
    buffer_load_dwordx4 v[80:83], v8, s[64:67], s44 offen offset:0 sc1
    v_exp_f32 v71, v71
    v_exp_f32 v72, v72
    v_exp_f32 v73, v73
    v_exp_f32 v74, v74
    v_smfmac_f32_32x32x32_bf16 v[144:159], v[96:99], v[64:71], v3
    v_exp_f32 v75, v75
    v_exp_f32 v76, v76
    s_mov_b64 exec, s[16:17]
    buffer_load_dwordx4 v[84:87], v11, s[64:67], s44 offen offset:1024 sc1
    buffer_load_dwordx4 v[88:91], v11, s[64:67], s44 offen offset:1536 sc1
    s_mov_b64 exec, -1
    v_exp_f32 v77, v77
    v_exp_f32 v78, v78
    v_exp_f32 v79, v79
    v_exp_f32 v48, v48
    v_exp_f32 v49, v49
    v_smfmac_f32_32x32x32_bf16 v[144:159], v[100:103], v[72:79], v3
    v_exp_f32 v50, v50
    v_exp_f32 v51, v51
    v_exp_f32 v52, v52
    v_mfma_f32_32x32x16_bf16 v[64:79], v[92:95], v[28:31], 0
    v_exp_f32 v53, v53
    v_exp_f32 v54, v54
    v_exp_f32 v55, v55
    v_exp_f32 v56, v56
    v_exp_f32 v57, v57
    v_exp_f32 v58, v58
    v_smfmac_f32_32x32x32_bf16 v[160:175], v[96:99], v[48:55], v3
    v_exp_f32 v59, v59
    v_exp_f32 v60, v60
    v_exp_f32 v61, v61
    v_exp_f32 v62, v62
    v_exp_f32 v63, v63
    v_exp_f32 v64, v64
    v_exp_f32 v65, v65
    v_smfmac_f32_32x32x32_bf16 v[160:175], v[100:103], v[56:63], v3
    v_exp_f32 v66, v66
    v_exp_f32 v67, v67
    v_exp_f32 v68, v68
    v_mfma_f32_32x32x16_bf16 v[48:63], v[92:95], v[32:35], 0
    v_exp_f32 v69, v69
    v_exp_f32 v70, v70
    v_exp_f32 v71, v71
    v_exp_f32 v72, v72
    v_exp_f32 v73, v73
    v_exp_f32 v74, v74
    v_smfmac_f32_32x32x32_bf16 v[176:191], v[96:99], v[64:71], v3
    v_exp_f32 v75, v75
    v_exp_f32 v76, v76
    v_exp_f32 v77, v77
    v_exp_f32 v78, v78
    v_exp_f32 v79, v79
    v_exp_f32 v48, v48
    v_exp_f32 v49, v49
    v_smfmac_f32_32x32x32_bf16 v[176:191], v[100:103], v[72:79], v3
    v_exp_f32 v50, v50
    v_exp_f32 v51, v51
    v_exp_f32 v52, v52
    v_mfma_f32_32x32x16_bf16 v[64:79], v[92:95], v[36:39], 0
    v_exp_f32 v53, v53
    v_exp_f32 v54, v54
    v_exp_f32 v55, v55
    v_exp_f32 v56, v56
    v_exp_f32 v57, v57
    v_exp_f32 v58, v58
    v_smfmac_f32_32x32x32_bf16 v[192:207], v[96:99], v[48:55], v3
    v_exp_f32 v59, v59
    v_exp_f32 v60, v60
    v_exp_f32 v61, v61
    v_exp_f32 v62, v62
    v_exp_f32 v63, v63
    v_exp_f32 v64, v64
    v_exp_f32 v65, v65
    v_smfmac_f32_32x32x32_bf16 v[192:207], v[100:103], v[56:63], v3
    v_exp_f32 v66, v66
    v_exp_f32 v67, v67
    v_exp_f32 v68, v68
    v_mfma_f32_32x32x16_bf16 v[48:63], v[92:95], v[40:43], 0
    v_exp_f32 v69, v69
    v_exp_f32 v70, v70
    v_exp_f32 v71, v71
    v_exp_f32 v72, v72
    v_exp_f32 v73, v73
    v_exp_f32 v74, v74
    v_smfmac_f32_32x32x32_bf16 v[208:223], v[96:99], v[64:71], v3
    v_exp_f32 v75, v75
    v_exp_f32 v76, v76
    v_exp_f32 v77, v77
    v_exp_f32 v78, v78
    v_exp_f32 v79, v79
    v_exp_f32 v48, v48
    v_exp_f32 v49, v49
    v_smfmac_f32_32x32x32_bf16 v[208:223], v[100:103], v[72:79], v3
    v_exp_f32 v50, v50
    v_exp_f32 v51, v51
    v_exp_f32 v52, v52
    v_mfma_f32_32x32x16_bf16 v[64:79], v[92:95], v[44:47], 0
    v_exp_f32 v53, v53
    v_exp_f32 v54, v54
    v_exp_f32 v55, v55
    v_exp_f32 v56, v56
    v_exp_f32 v57, v57
    v_exp_f32 v58, v58
    v_smfmac_f32_32x32x32_bf16 v[224:239], v[96:99], v[48:55], v3
    v_exp_f32 v59, v59
    v_exp_f32 v60, v60
    v_exp_f32 v61, v61
    v_exp_f32 v62, v62
    v_exp_f32 v63, v63
    v_exp_f32 v64, v64
    v_exp_f32 v65, v65
    v_smfmac_f32_32x32x32_bf16 v[224:239], v[100:103], v[56:63], v3
    v_exp_f32 v66, v66
    v_exp_f32 v67, v67
    s_waitcnt vmcnt(6)
    v_exp_f32 v68, v68
    v_mfma_f32_32x32x16_bf16 v[48:63], v[104:107], v[16:19], 0
    v_exp_f32 v69, v69
    v_exp_f32 v70, v70
    v_exp_f32 v71, v71
    v_exp_f32 v72, v72
    v_exp_f32 v73, v73
    v_exp_f32 v74, v74
    v_smfmac_f32_32x32x32_bf16 v[240:255], v[96:99], v[64:71], v3
    v_exp_f32 v75, v75
    v_exp_f32 v76, v76
    v_exp_f32 v77, v77
    v_exp_f32 v78, v78
    v_exp_f32 v79, v79
    v_exp_f32 v48, v48
    v_exp_f32 v49, v49
    v_smfmac_f32_32x32x32_bf16 v[240:255], v[100:103], v[72:79], v3
    v_exp_f32 v50, v50
    v_exp_f32 v51, v51
    v_exp_f32 v52, v52
    v_mfma_f32_32x32x16_bf16 v[64:79], v[104:107], v[20:23], 0
    v_exp_f32 v53, v53
    v_exp_f32 v54, v54
    v_exp_f32 v55, v55
    v_exp_f32 v56, v56
    v_exp_f32 v57, v57
    v_exp_f32 v58, v58
    v_smfmac_f32_32x32x32_bf16 v[128:143], v[108:111], v[48:55], v3
    v_exp_f32 v59, v59
    v_exp_f32 v60, v60
    v_exp_f32 v61, v61
    v_exp_f32 v62, v62
    v_exp_f32 v63, v63
    v_exp_f32 v64, v64
    v_exp_f32 v65, v65
    v_smfmac_f32_32x32x32_bf16 v[128:143], v[112:115], v[56:63], v3
    v_exp_f32 v66, v66
    v_exp_f32 v67, v67
    v_exp_f32 v68, v68
    v_mfma_f32_32x32x16_bf16 v[48:63], v[104:107], v[24:27], 0
    v_exp_f32 v69, v69
    v_exp_f32 v70, v70
    buffer_load_dwordx4 v[92:95], v8, s[64:67], s44 offen offset:2048 sc1
    v_exp_f32 v71, v71
    v_exp_f32 v72, v72
    v_exp_f32 v73, v73
    v_exp_f32 v74, v74
    v_smfmac_f32_32x32x32_bf16 v[144:159], v[108:111], v[64:71], v3
    v_exp_f32 v75, v75
    v_exp_f32 v76, v76
    s_mov_b64 exec, s[16:17]
    buffer_load_dwordx4 v[96:99], v11, s[64:67], s44 offen offset:3072 sc1
    buffer_load_dwordx4 v[100:103], v11, s[64:67], s44 offen offset:3584 sc1
    s_mov_b64 exec, -1
    v_exp_f32 v77, v77
    v_exp_f32 v78, v78
    v_exp_f32 v79, v79
    v_exp_f32 v48, v48
    v_exp_f32 v49, v49
    v_smfmac_f32_32x32x32_bf16 v[144:159], v[112:115], v[72:79], v3
    v_exp_f32 v50, v50
    v_exp_f32 v51, v51
    v_exp_f32 v52, v52
    v_mfma_f32_32x32x16_bf16 v[64:79], v[104:107], v[28:31], 0
    v_exp_f32 v53, v53
    v_exp_f32 v54, v54
    v_exp_f32 v55, v55
    v_exp_f32 v56, v56
    v_exp_f32 v57, v57
    v_exp_f32 v58, v58
    v_smfmac_f32_32x32x32_bf16 v[160:175], v[108:111], v[48:55], v3
    v_exp_f32 v59, v59
    v_exp_f32 v60, v60
    v_exp_f32 v61, v61
    v_exp_f32 v62, v62
    v_exp_f32 v63, v63
    v_exp_f32 v64, v64
    v_exp_f32 v65, v65
    v_smfmac_f32_32x32x32_bf16 v[160:175], v[112:115], v[56:63], v3
    v_exp_f32 v66, v66
    v_exp_f32 v67, v67
    v_exp_f32 v68, v68
    v_mfma_f32_32x32x16_bf16 v[48:63], v[104:107], v[32:35], 0
    v_exp_f32 v69, v69
    v_exp_f32 v70, v70
    v_exp_f32 v71, v71
    v_exp_f32 v72, v72
    v_exp_f32 v73, v73
    v_exp_f32 v74, v74
    v_smfmac_f32_32x32x32_bf16 v[176:191], v[108:111], v[64:71], v3
    v_exp_f32 v75, v75
    v_exp_f32 v76, v76
    v_exp_f32 v77, v77
    v_exp_f32 v78, v78
    v_exp_f32 v79, v79
    v_exp_f32 v48, v48
    v_exp_f32 v49, v49
    v_smfmac_f32_32x32x32_bf16 v[176:191], v[112:115], v[72:79], v3
    v_exp_f32 v50, v50
    v_exp_f32 v51, v51
    v_exp_f32 v52, v52
    v_mfma_f32_32x32x16_bf16 v[64:79], v[104:107], v[36:39], 0
    v_exp_f32 v53, v53
    v_exp_f32 v54, v54
    v_exp_f32 v55, v55
    v_exp_f32 v56, v56
    v_exp_f32 v57, v57
    v_exp_f32 v58, v58
    v_smfmac_f32_32x32x32_bf16 v[192:207], v[108:111], v[48:55], v3
    v_exp_f32 v59, v59
    v_exp_f32 v60, v60
    v_exp_f32 v61, v61
    v_exp_f32 v62, v62
    v_exp_f32 v63, v63
    v_exp_f32 v64, v64
    v_exp_f32 v65, v65
    v_smfmac_f32_32x32x32_bf16 v[192:207], v[112:115], v[56:63], v3
    v_exp_f32 v66, v66
    v_exp_f32 v67, v67
    v_exp_f32 v68, v68
    v_mfma_f32_32x32x16_bf16 v[48:63], v[104:107], v[40:43], 0
    v_exp_f32 v69, v69
    v_exp_f32 v70, v70
    v_exp_f32 v71, v71
    v_exp_f32 v72, v72
    v_exp_f32 v73, v73
    v_exp_f32 v74, v74
    v_smfmac_f32_32x32x32_bf16 v[208:223], v[108:111], v[64:71], v3
L_pga2:
    s_cbranch_execz L_rta2
    v_exp_f32 v75, v75
    v_exp_f32 v76, v76
    v_exp_f32 v77, v77
    v_exp_f32 v78, v78
    v_exp_f32 v79, v79
    v_exp_f32 v48, v48
    v_exp_f32 v49, v49
    v_smfmac_f32_32x32x32_bf16 v[208:223], v[112:115], v[72:79], v3
    v_exp_f32 v50, v50
    v_exp_f32 v51, v51
    v_exp_f32 v52, v52
    v_mfma_f32_32x32x16_bf16 v[64:79], v[104:107], v[44:47], 0
    v_exp_f32 v53, v53
    v_exp_f32 v54, v54
    v_exp_f32 v55, v55
    v_exp_f32 v56, v56
    v_exp_f32 v57, v57
    v_exp_f32 v58, v58
    v_smfmac_f32_32x32x32_bf16 v[224:239], v[108:111], v[48:55], v3
    v_exp_f32 v59, v59
    v_exp_f32 v60, v60
    v_exp_f32 v61, v61
    v_exp_f32 v62, v62
    v_exp_f32 v63, v63
    v_exp_f32 v64, v64
    v_exp_f32 v65, v65
    v_smfmac_f32_32x32x32_bf16 v[224:239], v[112:115], v[56:63], v3
    v_exp_f32 v66, v66
    v_exp_f32 v67, v67
    s_waitcnt vmcnt(6)
    v_exp_f32 v68, v68
    v_mfma_f32_32x32x16_bf16 v[48:63], v[116:119], v[16:19], 0
    v_exp_f32 v69, v69
    v_exp_f32 v70, v70
    v_exp_f32 v71, v71
    v_exp_f32 v72, v72
    v_exp_f32 v73, v73
    v_exp_f32 v74, v74
    v_smfmac_f32_32x32x32_bf16 v[240:255], v[108:111], v[64:71], v3
    v_exp_f32 v75, v75
    v_exp_f32 v76, v76
    v_exp_f32 v77, v77
    v_exp_f32 v78, v78
    v_exp_f32 v79, v79
    v_exp_f32 v48, v48
    v_exp_f32 v49, v49
    v_smfmac_f32_32x32x32_bf16 v[240:255], v[112:115], v[72:79], v3
    v_exp_f32 v50, v50
    v_exp_f32 v51, v51
    v_exp_f32 v52, v52
    v_mfma_f32_32x32x16_bf16 v[64:79], v[116:119], v[20:23], 0
    v_exp_f32 v53, v53
    v_exp_f32 v54, v54
    v_exp_f32 v55, v55
    v_exp_f32 v56, v56
    v_exp_f32 v57, v57
    v_exp_f32 v58, v58
    v_smfmac_f32_32x32x32_bf16 v[128:143], v[120:123], v[48:55], v3
    v_exp_f32 v59, v59
    v_exp_f32 v60, v60
    v_exp_f32 v61, v61
    v_exp_f32 v62, v62
    v_exp_f32 v63, v63
    v_exp_f32 v64, v64
    v_exp_f32 v65, v65
    v_smfmac_f32_32x32x32_bf16 v[128:143], v[124:127], v[56:63], v3
    v_exp_f32 v66, v66
    v_exp_f32 v67, v67
    v_exp_f32 v68, v68
    v_mfma_f32_32x32x16_bf16 v[48:63], v[116:119], v[24:27], 0
    v_exp_f32 v69, v69
    v_exp_f32 v70, v70
    buffer_load_dwordx4 v[104:107], v8, s[64:67], s45 offen offset:0 sc1
    v_exp_f32 v71, v71
    v_exp_f32 v72, v72
    v_exp_f32 v73, v73
    v_exp_f32 v74, v74
    v_smfmac_f32_32x32x32_bf16 v[144:159], v[120:123], v[64:71], v3
    v_exp_f32 v75, v75
    v_exp_f32 v76, v76
    s_mov_b64 exec, s[16:17]
    buffer_load_dwordx4 v[108:111], v11, s[64:67], s45 offen offset:1024 sc1
    buffer_load_dwordx4 v[112:115], v11, s[64:67], s45 offen offset:1536 sc1
    s_mov_b64 exec, -1
    v_exp_f32 v77, v77
    v_exp_f32 v78, v78
    v_exp_f32 v79, v79
    v_exp_f32 v48, v48
    v_exp_f32 v49, v49
    v_smfmac_f32_32x32x32_bf16 v[144:159], v[124:127], v[72:79], v3
    v_exp_f32 v50, v50
    v_exp_f32 v51, v51
    v_exp_f32 v52, v52
    v_mfma_f32_32x32x16_bf16 v[64:79], v[116:119], v[28:31], 0
    v_exp_f32 v53, v53
    v_exp_f32 v54, v54
    v_exp_f32 v55, v55
    v_exp_f32 v56, v56
    v_exp_f32 v57, v57
    v_exp_f32 v58, v58
    v_smfmac_f32_32x32x32_bf16 v[160:175], v[120:123], v[48:55], v3
    v_exp_f32 v59, v59
    v_exp_f32 v60, v60
    v_exp_f32 v61, v61
    v_exp_f32 v62, v62
    v_exp_f32 v63, v63
    v_exp_f32 v64, v64
    v_exp_f32 v65, v65
    v_smfmac_f32_32x32x32_bf16 v[160:175], v[124:127], v[56:63], v3
    v_exp_f32 v66, v66
    v_exp_f32 v67, v67
    v_exp_f32 v68, v68
    v_mfma_f32_32x32x16_bf16 v[48:63], v[116:119], v[32:35], 0
    v_exp_f32 v69, v69
    v_exp_f32 v70, v70
    v_exp_f32 v71, v71
    v_exp_f32 v72, v72
    v_exp_f32 v73, v73
    v_exp_f32 v74, v74
    v_smfmac_f32_32x32x32_bf16 v[176:191], v[120:123], v[64:71], v3
    v_exp_f32 v75, v75
    v_exp_f32 v76, v76
    v_exp_f32 v77, v77
    v_exp_f32 v78, v78
    v_exp_f32 v79, v79
    v_exp_f32 v48, v48
    v_exp_f32 v49, v49
    v_smfmac_f32_32x32x32_bf16 v[176:191], v[124:127], v[72:79], v3
    v_exp_f32 v50, v50
    v_exp_f32 v51, v51
    v_exp_f32 v52, v52
    v_mfma_f32_32x32x16_bf16 v[64:79], v[116:119], v[36:39], 0
    v_exp_f32 v53, v53
    v_exp_f32 v54, v54
    v_exp_f32 v55, v55
    v_exp_f32 v56, v56
    v_exp_f32 v57, v57
    v_exp_f32 v58, v58
    v_smfmac_f32_32x32x32_bf16 v[192:207], v[120:123], v[48:55], v3
    v_exp_f32 v59, v59
    v_exp_f32 v60, v60
    v_exp_f32 v61, v61
    v_exp_f32 v62, v62
    v_exp_f32 v63, v63
    v_exp_f32 v64, v64
    v_exp_f32 v65, v65
    v_smfmac_f32_32x32x32_bf16 v[192:207], v[124:127], v[56:63], v3
    v_exp_f32 v66, v66
    v_exp_f32 v67, v67
    v_exp_f32 v68, v68
    v_mfma_f32_32x32x16_bf16 v[48:63], v[116:119], v[40:43], 0
    v_exp_f32 v69, v69
    v_exp_f32 v70, v70
    v_exp_f32 v71, v71
    v_exp_f32 v72, v72
    v_exp_f32 v73, v73
    v_exp_f32 v74, v74
    v_smfmac_f32_32x32x32_bf16 v[208:223], v[120:123], v[64:71], v3
    v_exp_f32 v75, v75
    v_exp_f32 v76, v76
    v_exp_f32 v77, v77
    v_exp_f32 v78, v78
    v_exp_f32 v79, v79
    v_exp_f32 v48, v48
    v_exp_f32 v49, v49
    v_smfmac_f32_32x32x32_bf16 v[208:223], v[124:127], v[72:79], v3
    v_exp_f32 v50, v50
    v_exp_f32 v51, v51
    v_exp_f32 v52, v52
    v_mfma_f32_32x32x16_bf16 v[64:79], v[116:119], v[44:47], 0
    v_exp_f32 v53, v53
    v_exp_f32 v54, v54
    v_exp_f32 v55, v55
    v_exp_f32 v56, v56
    v_exp_f32 v57, v57
    v_exp_f32 v58, v58
    v_smfmac_f32_32x32x32_bf16 v[224:239], v[120:123], v[48:55], v3
    v_exp_f32 v59, v59
    v_exp_f32 v60, v60
    v_exp_f32 v61, v61
    v_exp_f32 v62, v62
    v_exp_f32 v63, v63
    v_exp_f32 v64, v64
    v_exp_f32 v65, v65
    v_smfmac_f32_32x32x32_bf16 v[224:239], v[124:127], v[56:63], v3
    v_exp_f32 v66, v66
    v_exp_f32 v67, v67
    s_waitcnt vmcnt(6)
    v_exp_f32 v68, v68
    v_mfma_f32_32x32x16_bf16 v[48:63], v[80:83], v[16:19], 0
    v_exp_f32 v69, v69
    v_exp_f32 v70, v70
    v_exp_f32 v71, v71
    v_exp_f32 v72, v72
    v_exp_f32 v73, v73
    v_exp_f32 v74, v74
    v_smfmac_f32_32x32x32_bf16 v[240:255], v[120:123], v[64:71], v3
    v_exp_f32 v75, v75
    v_exp_f32 v76, v76
    v_exp_f32 v77, v77
    v_exp_f32 v78, v78
    v_exp_f32 v79, v79
    v_exp_f32 v48, v48
    v_exp_f32 v49, v49
    v_smfmac_f32_32x32x32_bf16 v[240:255], v[124:127], v[72:79], v3
    v_exp_f32 v50, v50
    v_exp_f32 v51, v51
    v_exp_f32 v52, v52
    v_mfma_f32_32x32x16_bf16 v[64:79], v[80:83], v[20:23], 0
    v_exp_f32 v53, v53
    v_exp_f32 v54, v54
    v_exp_f32 v55, v55
    v_exp_f32 v56, v56
    v_exp_f32 v57, v57
    v_exp_f32 v58, v58
    v_smfmac_f32_32x32x32_bf16 v[128:143], v[84:87], v[48:55], v3
    v_exp_f32 v59, v59
    v_exp_f32 v60, v60
    v_exp_f32 v61, v61
    v_exp_f32 v62, v62
    v_exp_f32 v63, v63
    v_exp_f32 v64, v64
    v_exp_f32 v65, v65
    v_smfmac_f32_32x32x32_bf16 v[128:143], v[88:91], v[56:63], v3
    v_exp_f32 v66, v66
    v_exp_f32 v67, v67
    v_exp_f32 v68, v68
    v_mfma_f32_32x32x16_bf16 v[48:63], v[80:83], v[24:27], 0
    v_exp_f32 v69, v69
    v_exp_f32 v70, v70
    buffer_load_dwordx4 v[116:119], v8, s[64:67], s45 offen offset:2048 sc1
    v_exp_f32 v71, v71
    v_exp_f32 v72, v72
    v_exp_f32 v73, v73
    v_exp_f32 v74, v74
    v_smfmac_f32_32x32x32_bf16 v[144:159], v[84:87], v[64:71], v3
    v_exp_f32 v75, v75
    v_exp_f32 v76, v76
    s_mov_b64 exec, s[16:17]
    buffer_load_dwordx4 v[120:123], v11, s[64:67], s45 offen offset:3072 sc1
    buffer_load_dwordx4 v[124:127], v11, s[64:67], s45 offen offset:3584 sc1
    s_mov_b64 exec, -1
    v_exp_f32 v77, v77
    v_exp_f32 v78, v78
    v_exp_f32 v79, v79
    v_exp_f32 v48, v48
    v_exp_f32 v49, v49
    v_smfmac_f32_32x32x32_bf16 v[144:159], v[88:91], v[72:79], v3
    v_exp_f32 v50, v50
    v_exp_f32 v51, v51
    v_exp_f32 v52, v52
    v_mfma_f32_32x32x16_bf16 v[64:79], v[80:83], v[28:31], 0
    v_exp_f32 v53, v53
    v_exp_f32 v54, v54
    v_exp_f32 v55, v55
    v_exp_f32 v56, v56
    v_exp_f32 v57, v57
    v_exp_f32 v58, v58
    v_smfmac_f32_32x32x32_bf16 v[160:175], v[84:87], v[48:55], v3
    v_exp_f32 v59, v59
    v_exp_f32 v60, v60
    v_exp_f32 v61, v61
    v_exp_f32 v62, v62
    v_exp_f32 v63, v63
    v_exp_f32 v64, v64
    v_exp_f32 v65, v65
    v_smfmac_f32_32x32x32_bf16 v[160:175], v[88:91], v[56:63], v3
    v_exp_f32 v66, v66
    v_exp_f32 v67, v67
    v_exp_f32 v68, v68
    v_mfma_f32_32x32x16_bf16 v[48:63], v[80:83], v[32:35], 0
    v_exp_f32 v69, v69
    v_exp_f32 v70, v70
    v_exp_f32 v71, v71
    v_exp_f32 v72, v72
    v_exp_f32 v73, v73
    v_exp_f32 v74, v74
    v_smfmac_f32_32x32x32_bf16 v[176:191], v[84:87], v[64:71], v3
    v_exp_f32 v75, v75
    v_exp_f32 v76, v76
    v_exp_f32 v77, v77
    v_exp_f32 v78, v78
    v_exp_f32 v79, v79
    v_exp_f32 v48, v48
    v_exp_f32 v49, v49
    v_smfmac_f32_32x32x32_bf16 v[176:191], v[88:91], v[72:79], v3
    v_exp_f32 v50, v50
    v_exp_f32 v51, v51
    v_exp_f32 v52, v52
    v_mfma_f32_32x32x16_bf16 v[64:79], v[80:83], v[36:39], 0
    v_exp_f32 v53, v53
    v_exp_f32 v54, v54
    v_exp_f32 v55, v55
    v_exp_f32 v56, v56
    v_exp_f32 v57, v57
    v_exp_f32 v58, v58
    v_smfmac_f32_32x32x32_bf16 v[192:207], v[84:87], v[48:55], v3
    v_exp_f32 v59, v59
    v_exp_f32 v60, v60
    v_exp_f32 v61, v61
    v_exp_f32 v62, v62
    v_exp_f32 v63, v63
    v_exp_f32 v64, v64
    v_exp_f32 v65, v65
    v_smfmac_f32_32x32x32_bf16 v[192:207], v[88:91], v[56:63], v3
    v_exp_f32 v66, v66
    v_exp_f32 v67, v67
    v_exp_f32 v68, v68
    v_mfma_f32_32x32x16_bf16 v[48:63], v[80:83], v[40:43], 0
    v_exp_f32 v69, v69
    v_exp_f32 v70, v70
    v_exp_f32 v71, v71
    v_exp_f32 v72, v72
    v_exp_f32 v73, v73
    v_exp_f32 v74, v74
    v_smfmac_f32_32x32x32_bf16 v[208:223], v[84:87], v[64:71], v3
    v_exp_f32 v75, v75
    v_exp_f32 v76, v76
    v_exp_f32 v77, v77
    v_exp_f32 v78, v78
    v_exp_f32 v79, v79
    v_exp_f32 v48, v48
    v_exp_f32 v49, v49
    v_smfmac_f32_32x32x32_bf16 v[208:223], v[88:91], v[72:79], v3
    v_exp_f32 v50, v50
    v_exp_f32 v51, v51
    v_exp_f32 v52, v52
    v_mfma_f32_32x32x16_bf16 v[64:79], v[80:83], v[44:47], 0
    v_exp_f32 v53, v53
    v_exp_f32 v54, v54
    v_exp_f32 v55, v55
    v_exp_f32 v56, v56
    v_exp_f32 v57, v57
    v_exp_f32 v58, v58
    v_smfmac_f32_32x32x32_bf16 v[224:239], v[84:87], v[48:55], v3
    v_exp_f32 v59, v59
    v_exp_f32 v60, v60
    v_exp_f32 v61, v61
    v_exp_f32 v62, v62
    v_exp_f32 v63, v63
    v_exp_f32 v64, v64
    v_exp_f32 v65, v65
    v_smfmac_f32_32x32x32_bf16 v[224:239], v[88:91], v[56:63], v3
    v_exp_f32 v66, v66
    v_exp_f32 v67, v67
    s_waitcnt vmcnt(6)
    v_exp_f32 v68, v68
    v_mfma_f32_32x32x16_bf16 v[48:63], v[92:95], v[16:19], 0
    v_exp_f32 v69, v69
    v_exp_f32 v70, v70
    v_exp_f32 v71, v71
    v_exp_f32 v72, v72
    v_exp_f32 v73, v73
    v_exp_f32 v74, v74
    v_smfmac_f32_32x32x32_bf16 v[240:255], v[84:87], v[64:71], v3
    v_exp_f32 v75, v75
    v_exp_f32 v76, v76
    v_exp_f32 v77, v77
    v_exp_f32 v78, v78
    v_exp_f32 v79, v79
    v_exp_f32 v48, v48
    v_exp_f32 v49, v49
    v_smfmac_f32_32x32x32_bf16 v[240:255], v[88:91], v[72:79], v3
    v_exp_f32 v50, v50
    v_exp_f32 v51, v51
    v_exp_f32 v52, v52
    v_mfma_f32_32x32x16_bf16 v[64:79], v[92:95], v[20:23], 0
    v_exp_f32 v53, v53
    v_exp_f32 v54, v54
    v_exp_f32 v55, v55
    v_exp_f32 v56, v56
    v_exp_f32 v57, v57
    v_exp_f32 v58, v58
    v_smfmac_f32_32x32x32_bf16 v[128:143], v[96:99], v[48:55], v3
    v_exp_f32 v59, v59
    v_exp_f32 v60, v60
    v_exp_f32 v61, v61
    v_exp_f32 v62, v62
    v_exp_f32 v63, v63
    v_exp_f32 v64, v64
    v_exp_f32 v65, v65
    v_smfmac_f32_32x32x32_bf16 v[128:143], v[100:103], v[56:63], v3
    v_exp_f32 v66, v66
    v_exp_f32 v67, v67
    v_exp_f32 v68, v68
    v_mfma_f32_32x32x16_bf16 v[48:63], v[92:95], v[24:27], 0
    v_exp_f32 v69, v69
    v_exp_f32 v70, v70
    buffer_load_dwordx4 v[80:83], v8, s[64:67], s46 offen offset:0 sc1
    v_exp_f32 v71, v71
    v_exp_f32 v72, v72
    v_exp_f32 v73, v73
    v_exp_f32 v74, v74
    v_smfmac_f32_32x32x32_bf16 v[144:159], v[96:99], v[64:71], v3
    v_exp_f32 v75, v75
    v_exp_f32 v76, v76
    s_mov_b64 exec, s[16:17]
    buffer_load_dwordx4 v[84:87], v11, s[64:67], s46 offen offset:1024 sc1
    buffer_load_dwordx4 v[88:91], v11, s[64:67], s46 offen offset:1536 sc1
    s_mov_b64 exec, -1
    v_exp_f32 v77, v77
    v_exp_f32 v78, v78
    v_exp_f32 v79, v79
    v_exp_f32 v48, v48
    v_exp_f32 v49, v49
    v_smfmac_f32_32x32x32_bf16 v[144:159], v[100:103], v[72:79], v3
    v_exp_f32 v50, v50
    v_exp_f32 v51, v51
    v_exp_f32 v52, v52
    v_mfma_f32_32x32x16_bf16 v[64:79], v[92:95], v[28:31], 0
    v_exp_f32 v53, v53
    v_exp_f32 v54, v54
    v_exp_f32 v55, v55
    v_exp_f32 v56, v56
    v_exp_f32 v57, v57
    v_exp_f32 v58, v58
    v_smfmac_f32_32x32x32_bf16 v[160:175], v[96:99], v[48:55], v3
    v_exp_f32 v59, v59
    v_exp_f32 v60, v60
    v_exp_f32 v61, v61
    v_exp_f32 v62, v62
    v_exp_f32 v63, v63
    v_exp_f32 v64, v64
    v_exp_f32 v65, v65
    v_smfmac_f32_32x32x32_bf16 v[160:175], v[100:103], v[56:63], v3
    v_exp_f32 v66, v66
    v_exp_f32 v67, v67
    v_exp_f32 v68, v68
    v_mfma_f32_32x32x16_bf16 v[48:63], v[92:95], v[32:35], 0
    v_exp_f32 v69, v69
    v_exp_f32 v70, v70
    v_exp_f32 v71, v71
    v_exp_f32 v72, v72
    v_exp_f32 v73, v73
    v_exp_f32 v74, v74
    v_smfmac_f32_32x32x32_bf16 v[176:191], v[96:99], v[64:71], v3
    v_exp_f32 v75, v75
    v_exp_f32 v76, v76
    v_exp_f32 v77, v77
    v_exp_f32 v78, v78
    v_exp_f32 v79, v79
    v_exp_f32 v48, v48
    v_exp_f32 v49, v49
    v_smfmac_f32_32x32x32_bf16 v[176:191], v[100:103], v[72:79], v3
    v_exp_f32 v50, v50
    v_exp_f32 v51, v51
    v_exp_f32 v52, v52
    v_mfma_f32_32x32x16_bf16 v[64:79], v[92:95], v[36:39], 0
    v_exp_f32 v53, v53
    v_exp_f32 v54, v54
    v_exp_f32 v55, v55
    v_exp_f32 v56, v56
    v_exp_f32 v57, v57
    v_exp_f32 v58, v58
    v_smfmac_f32_32x32x32_bf16 v[192:207], v[96:99], v[48:55], v3
    v_exp_f32 v59, v59
    v_exp_f32 v60, v60
    v_exp_f32 v61, v61
    v_exp_f32 v62, v62
    v_exp_f32 v63, v63
    v_exp_f32 v64, v64
    v_exp_f32 v65, v65
    v_smfmac_f32_32x32x32_bf16 v[192:207], v[100:103], v[56:63], v3
    v_exp_f32 v66, v66
    v_exp_f32 v67, v67
    v_exp_f32 v68, v68
    v_mfma_f32_32x32x16_bf16 v[48:63], v[92:95], v[40:43], 0
    v_exp_f32 v69, v69
    v_exp_f32 v70, v70
    v_exp_f32 v71, v71
    v_exp_f32 v72, v72
    v_exp_f32 v73, v73
    v_exp_f32 v74, v74
    v_smfmac_f32_32x32x32_bf16 v[208:223], v[96:99], v[64:71], v3
    v_exp_f32 v75, v75
    v_exp_f32 v76, v76
    v_exp_f32 v77, v77
    v_exp_f32 v78, v78
    v_exp_f32 v79, v79
    v_exp_f32 v48, v48
    v_exp_f32 v49, v49
    v_smfmac_f32_32x32x32_bf16 v[208:223], v[100:103], v[72:79], v3
    v_exp_f32 v50, v50
    v_exp_f32 v51, v51
    v_exp_f32 v52, v52
    v_mfma_f32_32x32x16_bf16 v[64:79], v[92:95], v[44:47], 0
    v_exp_f32 v53, v53
    v_exp_f32 v54, v54
    v_exp_f32 v55, v55
    v_exp_f32 v56, v56
    v_exp_f32 v57, v57
    v_exp_f32 v58, v58
    v_smfmac_f32_32x32x32_bf16 v[224:239], v[96:99], v[48:55], v3
    v_exp_f32 v59, v59
    v_exp_f32 v60, v60
    v_exp_f32 v61, v61
    v_exp_f32 v62, v62
    v_exp_f32 v63, v63
    v_exp_f32 v64, v64
    v_exp_f32 v65, v65
    v_smfmac_f32_32x32x32_bf16 v[224:239], v[100:103], v[56:63], v3
    v_exp_f32 v66, v66
    v_exp_f32 v67, v67
    s_waitcnt vmcnt(6)
    v_exp_f32 v68, v68
    v_mfma_f32_32x32x16_bf16 v[48:63], v[104:107], v[16:19], 0
    v_exp_f32 v69, v69
    v_exp_f32 v70, v70
    v_exp_f32 v71, v71
    v_exp_f32 v72, v72
    v_exp_f32 v73, v73
    v_exp_f32 v74, v74
    v_smfmac_f32_32x32x32_bf16 v[240:255], v[96:99], v[64:71], v3
    v_exp_f32 v75, v75
    v_exp_f32 v76, v76
    v_exp_f32 v77, v77
    v_exp_f32 v78, v78
    v_exp_f32 v79, v79
    v_exp_f32 v48, v48
    v_exp_f32 v49, v49
    v_smfmac_f32_32x32x32_bf16 v[240:255], v[100:103], v[72:79], v3
    v_exp_f32 v50, v50
    v_exp_f32 v51, v51
    v_exp_f32 v52, v52
    v_mfma_f32_32x32x16_bf16 v[64:79], v[104:107], v[20:23], 0
    v_exp_f32 v53, v53
    v_exp_f32 v54, v54
    v_exp_f32 v55, v55
    v_exp_f32 v56, v56
    v_exp_f32 v57, v57
    v_exp_f32 v58, v58
    v_smfmac_f32_32x32x32_bf16 v[128:143], v[108:111], v[48:55], v3
    v_exp_f32 v59, v59
    v_exp_f32 v60, v60
    v_exp_f32 v61, v61
    v_exp_f32 v62, v62
    v_exp_f32 v63, v63
    v_exp_f32 v64, v64
    v_exp_f32 v65, v65
    v_smfmac_f32_32x32x32_bf16 v[128:143], v[112:115], v[56:63], v3
    v_exp_f32 v66, v66
    v_exp_f32 v67, v67
    v_exp_f32 v68, v68
    v_mfma_f32_32x32x16_bf16 v[48:63], v[104:107], v[24:27], 0
    v_exp_f32 v69, v69
    v_exp_f32 v70, v70
    buffer_load_dwordx4 v[92:95], v8, s[64:67], s46 offen offset:2048 sc1
    v_exp_f32 v71, v71
    v_exp_f32 v72, v72
    v_exp_f32 v73, v73
    v_exp_f32 v74, v74
    v_smfmac_f32_32x32x32_bf16 v[144:159], v[108:111], v[64:71], v3
    v_exp_f32 v75, v75
    v_exp_f32 v76, v76
    s_mov_b64 exec, s[16:17]
    buffer_load_dwordx4 v[96:99], v11, s[64:67], s46 offen offset:3072 sc1
    buffer_load_dwordx4 v[100:103], v11, s[64:67], s46 offen offset:3584 sc1
    s_mov_b64 exec, -1
    v_exp_f32 v77, v77
    v_exp_f32 v78, v78
    v_exp_f32 v79, v79
    v_exp_f32 v48, v48
    v_exp_f32 v49, v49
    v_smfmac_f32_32x32x32_bf16 v[144:159], v[112:115], v[72:79], v3
    v_exp_f32 v50, v50
    v_exp_f32 v51, v51
    v_exp_f32 v52, v52
    v_mfma_f32_32x32x16_bf16 v[64:79], v[104:107], v[28:31], 0
    v_exp_f32 v53, v53
    v_exp_f32 v54, v54
    v_exp_f32 v55, v55
    v_exp_f32 v56, v56
    v_exp_f32 v57, v57
    v_exp_f32 v58, v58
    v_smfmac_f32_32x32x32_bf16 v[160:175], v[108:111], v[48:55], v3
    v_exp_f32 v59, v59
    v_exp_f32 v60, v60
    v_exp_f32 v61, v61
    v_exp_f32 v62, v62
    v_exp_f32 v63, v63
    v_exp_f32 v64, v64
    v_exp_f32 v65, v65
    v_smfmac_f32_32x32x32_bf16 v[160:175], v[112:115], v[56:63], v3
    v_exp_f32 v66, v66
    v_exp_f32 v67, v67
    v_exp_f32 v68, v68
    v_mfma_f32_32x32x16_bf16 v[48:63], v[104:107], v[32:35], 0
    v_exp_f32 v69, v69
    v_exp_f32 v70, v70
    v_exp_f32 v71, v71
    v_exp_f32 v72, v72
    v_exp_f32 v73, v73
    v_exp_f32 v74, v74
    v_smfmac_f32_32x32x32_bf16 v[176:191], v[108:111], v[64:71], v3
    v_exp_f32 v75, v75
    v_exp_f32 v76, v76
    v_exp_f32 v77, v77
    v_exp_f32 v78, v78
    v_exp_f32 v79, v79
    v_exp_f32 v48, v48
    v_exp_f32 v49, v49
    v_smfmac_f32_32x32x32_bf16 v[176:191], v[112:115], v[72:79], v3
    v_exp_f32 v50, v50
    v_exp_f32 v51, v51
    v_exp_f32 v52, v52
    v_mfma_f32_32x32x16_bf16 v[64:79], v[104:107], v[36:39], 0
    v_exp_f32 v53, v53
    v_exp_f32 v54, v54
    v_exp_f32 v55, v55
    v_exp_f32 v56, v56
    v_exp_f32 v57, v57
    v_exp_f32 v58, v58
    v_smfmac_f32_32x32x32_bf16 v[192:207], v[108:111], v[48:55], v3
    v_exp_f32 v59, v59
    v_exp_f32 v60, v60
    v_exp_f32 v61, v61
    v_exp_f32 v62, v62
    v_exp_f32 v63, v63
    v_exp_f32 v64, v64
    v_exp_f32 v65, v65
    v_smfmac_f32_32x32x32_bf16 v[192:207], v[112:115], v[56:63], v3
    v_exp_f32 v66, v66
    v_exp_f32 v67, v67
    v_exp_f32 v68, v68
    v_mfma_f32_32x32x16_bf16 v[48:63], v[104:107], v[40:43], 0
    v_exp_f32 v69, v69
    v_exp_f32 v70, v70
    v_exp_f32 v71, v71
    v_exp_f32 v72, v72
    v_exp_f32 v73, v73
    v_exp_f32 v74, v74
    v_smfmac_f32_32x32x32_bf16 v[208:223], v[108:111], v[64:71], v3
    v_exp_f32 v75, v75
    v_exp_f32 v76, v76
    v_exp_f32 v77, v77
    v_exp_f32 v78, v78
    v_exp_f32 v79, v79
    v_exp_f32 v48, v48
    v_exp_f32 v49, v49
    v_smfmac_f32_32x32x32_bf16 v[208:223], v[112:115], v[72:79], v3
    v_exp_f32 v50, v50
    v_exp_f32 v51, v51
    v_exp_f32 v52, v52
    v_mfma_f32_32x32x16_bf16 v[64:79], v[104:107], v[44:47], 0
    v_exp_f32 v53, v53
    v_exp_f32 v54, v54
    v_exp_f32 v55, v55
    v_exp_f32 v56, v56
    v_exp_f32 v57, v57
    v_exp_f32 v58, v58
    v_smfmac_f32_32x32x32_bf16 v[224:239], v[108:111], v[48:55], v3
    v_exp_f32 v59, v59
    v_exp_f32 v60, v60
    v_exp_f32 v61, v61
    v_exp_f32 v62, v62
    v_exp_f32 v63, v63
    v_exp_f32 v64, v64
    v_exp_f32 v65, v65
    v_smfmac_f32_32x32x32_bf16 v[224:239], v[112:115], v[56:63], v3
    v_exp_f32 v66, v66
    v_exp_f32 v67, v67
    s_waitcnt vmcnt(6)
    v_exp_f32 v68, v68
    v_mfma_f32_32x32x16_bf16 v[48:63], v[116:119], v[16:19], 0
    v_exp_f32 v69, v69
    v_exp_f32 v70, v70
    v_exp_f32 v71, v71
    v_exp_f32 v72, v72
    v_exp_f32 v73, v73
    v_exp_f32 v74, v74
    v_smfmac_f32_32x32x32_bf16 v[240:255], v[108:111], v[64:71], v3
    v_exp_f32 v75, v75
    v_exp_f32 v76, v76
    v_exp_f32 v77, v77
    v_exp_f32 v78, v78
    v_exp_f32 v79, v79
    v_exp_f32 v48, v48
    v_exp_f32 v49, v49
    v_smfmac_f32_32x32x32_bf16 v[240:255], v[112:115], v[72:79], v3
    v_exp_f32 v50, v50
    v_exp_f32 v51, v51
    v_exp_f32 v52, v52
    v_mfma_f32_32x32x16_bf16 v[64:79], v[116:119], v[20:23], 0
    v_exp_f32 v53, v53
    v_exp_f32 v54, v54
    v_exp_f32 v55, v55
    v_exp_f32 v56, v56
    v_exp_f32 v57, v57
    v_exp_f32 v58, v58
    v_smfmac_f32_32x32x32_bf16 v[128:143], v[120:123], v[48:55], v3
    v_exp_f32 v59, v59
    v_exp_f32 v60, v60
    v_exp_f32 v61, v61
    v_exp_f32 v62, v62
    v_exp_f32 v63, v63
    v_exp_f32 v64, v64
    v_exp_f32 v65, v65
    v_smfmac_f32_32x32x32_bf16 v[128:143], v[124:127], v[56:63], v3
    v_exp_f32 v66, v66
    v_exp_f32 v67, v67
    v_exp_f32 v68, v68
    v_mfma_f32_32x32x16_bf16 v[48:63], v[116:119], v[24:27], 0
    v_exp_f32 v69, v69
    v_exp_f32 v70, v70
    buffer_load_dwordx4 v[104:107], v8, s[64:67], s47 offen offset:0 sc1
    v_exp_f32 v71, v71
    v_exp_f32 v72, v72
    v_exp_f32 v73, v73
    v_exp_f32 v74, v74
    v_smfmac_f32_32x32x32_bf16 v[144:159], v[120:123], v[64:71], v3
    v_exp_f32 v75, v75
    v_exp_f32 v76, v76
    s_mov_b64 exec, s[16:17]
    buffer_load_dwordx4 v[108:111], v11, s[64:67], s47 offen offset:1024 sc1
    buffer_load_dwordx4 v[112:115], v11, s[64:67], s47 offen offset:1536 sc1
    s_mov_b64 exec, -1
    v_exp_f32 v77, v77
    v_exp_f32 v78, v78
    v_exp_f32 v79, v79
    v_exp_f32 v48, v48
    v_exp_f32 v49, v49
    v_smfmac_f32_32x32x32_bf16 v[144:159], v[124:127], v[72:79], v3
    v_exp_f32 v50, v50
    v_exp_f32 v51, v51
    v_exp_f32 v52, v52
    v_mfma_f32_32x32x16_bf16 v[64:79], v[116:119], v[28:31], 0
    v_exp_f32 v53, v53
    v_exp_f32 v54, v54
    v_exp_f32 v55, v55
    v_exp_f32 v56, v56
    v_exp_f32 v57, v57
    v_exp_f32 v58, v58
    v_smfmac_f32_32x32x32_bf16 v[160:175], v[120:123], v[48:55], v3
    v_exp_f32 v59, v59
    v_exp_f32 v60, v60
    v_exp_f32 v61, v61
    v_exp_f32 v62, v62
    v_exp_f32 v63, v63
    v_exp_f32 v64, v64
    v_exp_f32 v65, v65
    v_smfmac_f32_32x32x32_bf16 v[160:175], v[124:127], v[56:63], v3
    v_exp_f32 v66, v66
    v_exp_f32 v67, v67
    v_exp_f32 v68, v68
    v_mfma_f32_32x32x16_bf16 v[48:63], v[116:119], v[32:35], 0
    v_exp_f32 v69, v69
    v_exp_f32 v70, v70
    v_exp_f32 v71, v71
    v_exp_f32 v72, v72
    v_exp_f32 v73, v73
    v_exp_f32 v74, v74
    v_smfmac_f32_32x32x32_bf16 v[176:191], v[120:123], v[64:71], v3
    v_exp_f32 v75, v75
    v_exp_f32 v76, v76
    v_exp_f32 v77, v77
    v_exp_f32 v78, v78
    v_exp_f32 v79, v79
    v_exp_f32 v48, v48
    v_exp_f32 v49, v49
    v_smfmac_f32_32x32x32_bf16 v[176:191], v[124:127], v[72:79], v3
    v_exp_f32 v50, v50
    v_exp_f32 v51, v51
    v_exp_f32 v52, v52
    v_mfma_f32_32x32x16_bf16 v[64:79], v[116:119], v[36:39], 0
    v_exp_f32 v53, v53
    v_exp_f32 v54, v54
    v_exp_f32 v55, v55
    v_exp_f32 v56, v56
    v_exp_f32 v57, v57
    v_exp_f32 v58, v58
    v_smfmac_f32_32x32x32_bf16 v[192:207], v[120:123], v[48:55], v3
    v_exp_f32 v59, v59
    v_exp_f32 v60, v60
    v_exp_f32 v61, v61
    v_exp_f32 v62, v62
    v_exp_f32 v63, v63
    v_exp_f32 v64, v64
    v_exp_f32 v65, v65
    v_smfmac_f32_32x32x32_bf16 v[192:207], v[124:127], v[56:63], v3
    v_exp_f32 v66, v66
    v_exp_f32 v67, v67
    v_exp_f32 v68, v68
    v_mfma_f32_32x32x16_bf16 v[48:63], v[116:119], v[40:43], 0
    v_exp_f32 v69, v69
    v_exp_f32 v70, v70
    v_exp_f32 v71, v71
    v_exp_f32 v72, v72
    v_exp_f32 v73, v73
    v_exp_f32 v74, v74
    v_smfmac_f32_32x32x32_bf16 v[208:223], v[120:123], v[64:71], v3
    v_exp_f32 v75, v75
    v_exp_f32 v76, v76
    v_exp_f32 v77, v77
    v_exp_f32 v78, v78
    v_exp_f32 v79, v79
    v_exp_f32 v48, v48
    v_exp_f32 v49, v49
    v_smfmac_f32_32x32x32_bf16 v[208:223], v[124:127], v[72:79], v3
    v_exp_f32 v50, v50
    v_exp_f32 v51, v51
    v_exp_f32 v52, v52
    v_mfma_f32_32x32x16_bf16 v[64:79], v[116:119], v[44:47], 0
    v_exp_f32 v53, v53
    v_exp_f32 v54, v54
    v_exp_f32 v55, v55
    v_exp_f32 v56, v56
    v_exp_f32 v57, v57
    v_exp_f32 v58, v58
    v_smfmac_f32_32x32x32_bf16 v[224:239], v[120:123], v[48:55], v3
    v_exp_f32 v59, v59
    v_exp_f32 v60, v60
    v_exp_f32 v61, v61
    v_exp_f32 v62, v62
    v_exp_f32 v63, v63
    v_exp_f32 v64, v64
    v_exp_f32 v65, v65
    v_smfmac_f32_32x32x32_bf16 v[224:239], v[124:127], v[56:63], v3
    v_exp_f32 v66, v66
    v_exp_f32 v67, v67
    s_waitcnt vmcnt(6)
    v_exp_f32 v68, v68
    v_mfma_f32_32x32x16_bf16 v[48:63], v[80:83], v[16:19], 0
    v_exp_f32 v69, v69
    v_exp_f32 v70, v70
    v_exp_f32 v71, v71
    v_exp_f32 v72, v72
    v_exp_f32 v73, v73
    v_exp_f32 v74, v74
    v_smfmac_f32_32x32x32_bf16 v[240:255], v[120:123], v[64:71], v3
    v_exp_f32 v75, v75
    v_exp_f32 v76, v76
    v_exp_f32 v77, v77
    v_exp_f32 v78, v78
    v_exp_f32 v79, v79
    v_exp_f32 v48, v48
    v_exp_f32 v49, v49
    v_smfmac_f32_32x32x32_bf16 v[240:255], v[124:127], v[72:79], v3
    v_exp_f32 v50, v50
    v_exp_f32 v51, v51
    v_exp_f32 v52, v52
    v_mfma_f32_32x32x16_bf16 v[64:79], v[80:83], v[20:23], 0
    v_exp_f32 v53, v53
    v_exp_f32 v54, v54
    v_exp_f32 v55, v55
    v_exp_f32 v56, v56
    v_exp_f32 v57, v57
    v_exp_f32 v58, v58
    v_smfmac_f32_32x32x32_bf16 v[128:143], v[84:87], v[48:55], v3
    v_exp_f32 v59, v59
    v_exp_f32 v60, v60
    v_exp_f32 v61, v61
    v_exp_f32 v62, v62
    v_exp_f32 v63, v63
    v_exp_f32 v64, v64
    v_exp_f32 v65, v65
    v_smfmac_f32_32x32x32_bf16 v[128:143], v[88:91], v[56:63], v3
    v_exp_f32 v66, v66
    v_exp_f32 v67, v67
    v_exp_f32 v68, v68
    v_mfma_f32_32x32x16_bf16 v[48:63], v[80:83], v[24:27], 0
    v_exp_f32 v69, v69
    v_exp_f32 v70, v70
    buffer_load_dwordx4 v[116:119], v8, s[64:67], s47 offen offset:2048 sc1
    v_exp_f32 v71, v71
    v_exp_f32 v72, v72
    v_exp_f32 v73, v73
    v_exp_f32 v74, v74
    v_smfmac_f32_32x32x32_bf16 v[144:159], v[84:87], v[64:71], v3
    v_exp_f32 v75, v75
    v_exp_f32 v76, v76
    s_mov_b64 exec, s[16:17]
    buffer_load_dwordx4 v[120:123], v11, s[64:67], s47 offen offset:3072 sc1
    buffer_load_dwordx4 v[124:127], v11, s[64:67], s47 offen offset:3584 sc1
L_pga3:
    s_cbranch_execz L_rta3
    s_mov_b64 exec, -1
    v_exp_f32 v77, v77
    v_exp_f32 v78, v78
    v_exp_f32 v79, v79
    v_exp_f32 v48, v48
    v_exp_f32 v49, v49
    v_smfmac_f32_32x32x32_bf16 v[144:159], v[88:91], v[72:79], v3
    v_exp_f32 v50, v50
    v_exp_f32 v51, v51
    v_exp_f32 v52, v52
    v_mfma_f32_32x32x16_bf16 v[64:79], v[80:83], v[28:31], 0
    v_exp_f32 v53, v53
    v_exp_f32 v54, v54
    v_exp_f32 v55, v55
    v_exp_f32 v56, v56
    v_exp_f32 v57, v57
    v_exp_f32 v58, v58
    v_smfmac_f32_32x32x32_bf16 v[160:175], v[84:87], v[48:55], v3
    v_exp_f32 v59, v59
    v_exp_f32 v60, v60
    v_exp_f32 v61, v61
    v_exp_f32 v62, v62
    v_exp_f32 v63, v63
    v_exp_f32 v64, v64
    v_exp_f32 v65, v65
    v_smfmac_f32_32x32x32_bf16 v[160:175], v[88:91], v[56:63], v3
    v_exp_f32 v66, v66
    v_exp_f32 v67, v67
    v_exp_f32 v68, v68
    v_mfma_f32_32x32x16_bf16 v[48:63], v[80:83], v[32:35], 0
    v_exp_f32 v69, v69
    v_exp_f32 v70, v70
    v_exp_f32 v71, v71
    v_exp_f32 v72, v72
    v_exp_f32 v73, v73
    v_exp_f32 v74, v74
    v_smfmac_f32_32x32x32_bf16 v[176:191], v[84:87], v[64:71], v3
    v_exp_f32 v75, v75
    v_exp_f32 v76, v76
    v_exp_f32 v77, v77
    v_exp_f32 v78, v78
    v_exp_f32 v79, v79
    v_exp_f32 v48, v48
    v_exp_f32 v49, v49
    v_smfmac_f32_32x32x32_bf16 v[176:191], v[88:91], v[72:79], v3
    v_exp_f32 v50, v50
    v_exp_f32 v51, v51
    v_exp_f32 v52, v52
    v_mfma_f32_32x32x16_bf16 v[64:79], v[80:83], v[36:39], 0
    v_exp_f32 v53, v53
    v_exp_f32 v54, v54
    v_exp_f32 v55, v55
    v_exp_f32 v56, v56
    v_exp_f32 v57, v57
    v_exp_f32 v58, v58
    v_smfmac_f32_32x32x32_bf16 v[192:207], v[84:87], v[48:55], v3
    v_exp_f32 v59, v59
    v_exp_f32 v60, v60
    v_exp_f32 v61, v61
    v_exp_f32 v62, v62
    v_exp_f32 v63, v63
    v_exp_f32 v64, v64
    v_exp_f32 v65, v65
    v_smfmac_f32_32x32x32_bf16 v[192:207], v[88:91], v[56:63], v3
    v_exp_f32 v66, v66
    v_exp_f32 v67, v67
    v_exp_f32 v68, v68
    v_mfma_f32_32x32x16_bf16 v[48:63], v[80:83], v[40:43], 0
    v_exp_f32 v69, v69
    v_exp_f32 v70, v70
    v_exp_f32 v71, v71
    v_exp_f32 v72, v72
    v_exp_f32 v73, v73
    v_exp_f32 v74, v74
    v_smfmac_f32_32x32x32_bf16 v[208:223], v[84:87], v[64:71], v3
    v_exp_f32 v75, v75
    v_exp_f32 v76, v76
    v_exp_f32 v77, v77
    v_exp_f32 v78, v78
    v_exp_f32 v79, v79
    v_exp_f32 v48, v48
    v_exp_f32 v49, v49
    v_smfmac_f32_32x32x32_bf16 v[208:223], v[88:91], v[72:79], v3
    v_exp_f32 v50, v50
    v_exp_f32 v51, v51
    v_exp_f32 v52, v52
    v_mfma_f32_32x32x16_bf16 v[64:79], v[80:83], v[44:47], 0
    v_exp_f32 v53, v53
    v_exp_f32 v54, v54
    v_exp_f32 v55, v55
    v_exp_f32 v56, v56
    v_exp_f32 v57, v57
    v_exp_f32 v58, v58
    v_smfmac_f32_32x32x32_bf16 v[224:239], v[84:87], v[48:55], v3
    v_exp_f32 v59, v59
    v_exp_f32 v60, v60
    v_exp_f32 v61, v61
    v_exp_f32 v62, v62
    v_exp_f32 v63, v63
    v_exp_f32 v64, v64
    v_exp_f32 v65, v65
    v_smfmac_f32_32x32x32_bf16 v[224:239], v[88:91], v[56:63], v3
    v_exp_f32 v66, v66
    v_exp_f32 v67, v67
    s_waitcnt vmcnt(6)
    v_exp_f32 v68, v68
    v_mfma_f32_32x32x16_bf16 v[48:63], v[92:95], v[16:19], 0
    v_exp_f32 v69, v69
    v_exp_f32 v70, v70
    v_exp_f32 v71, v71
    v_exp_f32 v72, v72
    v_exp_f32 v73, v73
    v_exp_f32 v74, v74
    v_smfmac_f32_32x32x32_bf16 v[240:255], v[84:87], v[64:71], v3
    v_exp_f32 v75, v75
    v_exp_f32 v76, v76
    v_exp_f32 v77, v77
    v_exp_f32 v78, v78
    v_exp_f32 v79, v79
    v_exp_f32 v48, v48
    v_exp_f32 v49, v49
    v_smfmac_f32_32x32x32_bf16 v[240:255], v[88:91], v[72:79], v3
    v_exp_f32 v50, v50
    v_exp_f32 v51, v51
    v_exp_f32 v52, v52
    v_mfma_f32_32x32x16_bf16 v[64:79], v[92:95], v[20:23], 0
    v_exp_f32 v53, v53
    v_exp_f32 v54, v54
    v_exp_f32 v55, v55
    v_exp_f32 v56, v56
    v_exp_f32 v57, v57
    v_exp_f32 v58, v58
    v_smfmac_f32_32x32x32_bf16 v[128:143], v[96:99], v[48:55], v3
    v_exp_f32 v59, v59
    v_exp_f32 v60, v60
    v_exp_f32 v61, v61
    v_exp_f32 v62, v62
    v_exp_f32 v63, v63
    v_exp_f32 v64, v64
    v_exp_f32 v65, v65
    v_smfmac_f32_32x32x32_bf16 v[128:143], v[100:103], v[56:63], v3
    v_exp_f32 v66, v66
    v_exp_f32 v67, v67
    v_exp_f32 v68, v68
    v_mfma_f32_32x32x16_bf16 v[48:63], v[92:95], v[24:27], 0
    v_exp_f32 v69, v69
    v_exp_f32 v70, v70
    v_exp_f32 v71, v71
    v_exp_f32 v72, v72
    v_exp_f32 v73, v73
    v_exp_f32 v74, v74
    v_smfmac_f32_32x32x32_bf16 v[144:159], v[96:99], v[64:71], v3
    v_exp_f32 v75, v75
    v_exp_f32 v76, v76
    v_exp_f32 v77, v77
    v_exp_f32 v78, v78
    v_exp_f32 v79, v79
    v_exp_f32 v48, v48
    v_exp_f32 v49, v49
    v_smfmac_f32_32x32x32_bf16 v[144:159], v[100:103], v[72:79], v3
    v_exp_f32 v50, v50
    v_exp_f32 v51, v51
    v_exp_f32 v52, v52
    v_mfma_f32_32x32x16_bf16 v[64:79], v[92:95], v[28:31], 0
    v_exp_f32 v53, v53
    v_exp_f32 v54, v54
    v_exp_f32 v55, v55
    v_exp_f32 v56, v56
    v_exp_f32 v57, v57
    v_exp_f32 v58, v58
    v_smfmac_f32_32x32x32_bf16 v[160:175], v[96:99], v[48:55], v3
    v_exp_f32 v59, v59
    v_exp_f32 v60, v60
    v_exp_f32 v61, v61
    v_exp_f32 v62, v62
    v_exp_f32 v63, v63
    v_exp_f32 v64, v64
    v_exp_f32 v65, v65
    v_smfmac_f32_32x32x32_bf16 v[160:175], v[100:103], v[56:63], v3
    v_exp_f32 v66, v66
    v_exp_f32 v67, v67
    v_exp_f32 v68, v68
    v_mfma_f32_32x32x16_bf16 v[48:63], v[92:95], v[32:35], 0
    v_exp_f32 v69, v69
    v_exp_f32 v70, v70
    v_exp_f32 v71, v71
    v_exp_f32 v72, v72
    v_exp_f32 v73, v73
    v_exp_f32 v74, v74
    v_smfmac_f32_32x32x32_bf16 v[176:191], v[96:99], v[64:71], v3
    v_exp_f32 v75, v75
    v_exp_f32 v76, v76
    v_exp_f32 v77, v77
    v_exp_f32 v78, v78
    v_exp_f32 v79, v79
    v_exp_f32 v48, v48
    v_exp_f32 v49, v49
    v_smfmac_f32_32x32x32_bf16 v[176:191], v[100:103], v[72:79], v3
    v_exp_f32 v50, v50
    v_exp_f32 v51, v51
    v_exp_f32 v52, v52
    v_mfma_f32_32x32x16_bf16 v[64:79], v[92:95], v[36:39], 0
    v_exp_f32 v53, v53
    v_exp_f32 v54, v54
    v_exp_f32 v55, v55
    v_exp_f32 v56, v56
    v_exp_f32 v57, v57
    v_exp_f32 v58, v58
    v_smfmac_f32_32x32x32_bf16 v[192:207], v[96:99], v[48:55], v3
    v_exp_f32 v59, v59
    v_exp_f32 v60, v60
    v_exp_f32 v61, v61
    v_exp_f32 v62, v62
    v_exp_f32 v63, v63
    v_exp_f32 v64, v64
    v_exp_f32 v65, v65
    v_smfmac_f32_32x32x32_bf16 v[192:207], v[100:103], v[56:63], v3
    v_exp_f32 v66, v66
    v_exp_f32 v67, v67
    v_exp_f32 v68, v68
    v_mfma_f32_32x32x16_bf16 v[48:63], v[92:95], v[40:43], 0
    v_exp_f32 v69, v69
    v_exp_f32 v70, v70
    v_exp_f32 v71, v71
    v_exp_f32 v72, v72
    v_exp_f32 v73, v73
    v_exp_f32 v74, v74
    v_smfmac_f32_32x32x32_bf16 v[208:223], v[96:99], v[64:71], v3
    v_exp_f32 v75, v75
    v_exp_f32 v76, v76
    v_exp_f32 v77, v77
    v_exp_f32 v78, v78
    v_exp_f32 v79, v79
    v_exp_f32 v48, v48
    v_exp_f32 v49, v49
    v_smfmac_f32_32x32x32_bf16 v[208:223], v[100:103], v[72:79], v3
    v_exp_f32 v50, v50
    v_exp_f32 v51, v51
    v_exp_f32 v52, v52
    v_mfma_f32_32x32x16_bf16 v[64:79], v[92:95], v[44:47], 0
    v_exp_f32 v53, v53
    v_exp_f32 v54, v54
    v_exp_f32 v55, v55
    v_exp_f32 v56, v56
    v_exp_f32 v57, v57
    v_exp_f32 v58, v58
    v_smfmac_f32_32x32x32_bf16 v[224:239], v[96:99], v[48:55], v3
    v_exp_f32 v59, v59
    v_exp_f32 v60, v60
    v_exp_f32 v61, v61
    v_exp_f32 v62, v62
    v_exp_f32 v63, v63
    v_exp_f32 v64, v64
    v_exp_f32 v65, v65
    v_smfmac_f32_32x32x32_bf16 v[224:239], v[100:103], v[56:63], v3
    v_exp_f32 v66, v66
    v_exp_f32 v67, v67
    s_waitcnt vmcnt(3)
    v_exp_f32 v68, v68
    v_mfma_f32_32x32x16_bf16 v[48:63], v[104:107], v[16:19], 0
    v_exp_f32 v69, v69
    v_exp_f32 v70, v70
    v_exp_f32 v71, v71
    v_exp_f32 v72, v72
    v_exp_f32 v73, v73
    v_exp_f32 v74, v74
    v_smfmac_f32_32x32x32_bf16 v[240:255], v[96:99], v[64:71], v3
    v_exp_f32 v75, v75
    v_exp_f32 v76, v76
    v_exp_f32 v77, v77
    v_exp_f32 v78, v78
    v_exp_f32 v79, v79
    v_exp_f32 v48, v48
    v_exp_f32 v49, v49
    v_smfmac_f32_32x32x32_bf16 v[240:255], v[100:103], v[72:79], v3
    v_exp_f32 v50, v50
    v_exp_f32 v51, v51
    v_exp_f32 v52, v52
    v_mfma_f32_32x32x16_bf16 v[64:79], v[104:107], v[20:23], 0
    v_exp_f32 v53, v53
    v_exp_f32 v54, v54
    v_exp_f32 v55, v55
    v_exp_f32 v56, v56
    v_exp_f32 v57, v57
    v_exp_f32 v58, v58
    v_smfmac_f32_32x32x32_bf16 v[128:143], v[108:111], v[48:55], v3
    v_exp_f32 v59, v59
    v_exp_f32 v60, v60
    v_exp_f32 v61, v61
    v_exp_f32 v62, v62
    v_exp_f32 v63, v63
    v_exp_f32 v64, v64
    v_exp_f32 v65, v65
    v_smfmac_f32_32x32x32_bf16 v[128:143], v[112:115], v[56:63], v3
    v_exp_f32 v66, v66
    v_exp_f32 v67, v67
    v_exp_f32 v68, v68
    v_mfma_f32_32x32x16_bf16 v[48:63], v[104:107], v[24:27], 0
    v_exp_f32 v69, v69
    v_exp_f32 v70, v70
    v_exp_f32 v71, v71
    v_exp_f32 v72, v72
    v_exp_f32 v73, v73
    v_exp_f32 v74, v74
    v_smfmac_f32_32x32x32_bf16 v[144:159], v[108:111], v[64:71], v3
    v_exp_f32 v75, v75
    v_exp_f32 v76, v76
    v_exp_f32 v77, v77
    v_exp_f32 v78, v78
    v_exp_f32 v79, v79
    v_exp_f32 v48, v48
    v_exp_f32 v49, v49
    v_smfmac_f32_32x32x32_bf16 v[144:159], v[112:115], v[72:79], v3
    v_exp_f32 v50, v50
    v_exp_f32 v51, v51
    v_exp_f32 v52, v52
    v_mfma_f32_32x32x16_bf16 v[64:79], v[104:107], v[28:31], 0
    v_exp_f32 v53, v53
    v_exp_f32 v54, v54
    v_exp_f32 v55, v55
    v_exp_f32 v56, v56
    v_exp_f32 v57, v57
    v_exp_f32 v58, v58
    v_smfmac_f32_32x32x32_bf16 v[160:175], v[108:111], v[48:55], v3
    v_exp_f32 v59, v59
    v_exp_f32 v60, v60
    v_exp_f32 v61, v61
    v_exp_f32 v62, v62
    v_exp_f32 v63, v63
    v_exp_f32 v64, v64
    v_exp_f32 v65, v65
    v_smfmac_f32_32x32x32_bf16 v[160:175], v[112:115], v[56:63], v3
    v_exp_f32 v66, v66
    v_exp_f32 v67, v67
    v_exp_f32 v68, v68
    v_mfma_f32_32x32x16_bf16 v[48:63], v[104:107], v[32:35], 0
    v_exp_f32 v69, v69
    v_exp_f32 v70, v70
    v_exp_f32 v71, v71
    v_exp_f32 v72, v72
    v_exp_f32 v73, v73
    v_exp_f32 v74, v74
    v_smfmac_f32_32x32x32_bf16 v[176:191], v[108:111], v[64:71], v3
    v_exp_f32 v75, v75
    v_exp_f32 v76, v76
    v_exp_f32 v77, v77
    v_exp_f32 v78, v78
    v_exp_f32 v79, v79
    v_exp_f32 v48, v48
    v_exp_f32 v49, v49
    v_smfmac_f32_32x32x32_bf16 v[176:191], v[112:115], v[72:79], v3
    v_exp_f32 v50, v50
    v_exp_f32 v51, v51
    v_exp_f32 v52, v52
    v_mfma_f32_32x32x16_bf16 v[64:79], v[104:107], v[36:39], 0
    v_exp_f32 v53, v53
    v_exp_f32 v54, v54
    v_exp_f32 v55, v55
    v_exp_f32 v56, v56
    v_exp_f32 v57, v57
    v_exp_f32 v58, v58
    v_smfmac_f32_32x32x32_bf16 v[192:207], v[108:111], v[48:55], v3
    v_exp_f32 v59, v59
    v_exp_f32 v60, v60
    v_exp_f32 v61, v61
    v_exp_f32 v62, v62
    v_exp_f32 v63, v63
    v_exp_f32 v64, v64
    v_exp_f32 v65, v65
    v_smfmac_f32_32x32x32_bf16 v[192:207], v[112:115], v[56:63], v3
    v_exp_f32 v66, v66
    v_exp_f32 v67, v67
    v_exp_f32 v68, v68
    v_mfma_f32_32x32x16_bf16 v[48:63], v[104:107], v[40:43], 0
    v_exp_f32 v69, v69
    v_exp_f32 v70, v70
    v_exp_f32 v71, v71
    v_exp_f32 v72, v72
    v_exp_f32 v73, v73
    v_exp_f32 v74, v74
    v_smfmac_f32_32x32x32_bf16 v[208:223], v[108:111], v[64:71], v3
    v_exp_f32 v75, v75
    v_exp_f32 v76, v76
    v_exp_f32 v77, v77
    v_exp_f32 v78, v78
    v_exp_f32 v79, v79
    v_exp_f32 v48, v48
    v_exp_f32 v49, v49
    v_smfmac_f32_32x32x32_bf16 v[208:223], v[112:115], v[72:79], v3
    v_exp_f32 v50, v50
    v_exp_f32 v51, v51
    v_exp_f32 v52, v52
    v_mfma_f32_32x32x16_bf16 v[64:79], v[104:107], v[44:47], 0
    v_exp_f32 v53, v53
    v_exp_f32 v54, v54
    v_exp_f32 v55, v55
    v_exp_f32 v56, v56
    v_exp_f32 v57, v57
    v_exp_f32 v58, v58
    v_smfmac_f32_32x32x32_bf16 v[224:239], v[108:111], v[48:55], v3
    v_exp_f32 v59, v59
    v_exp_f32 v60, v60
    v_exp_f32 v61, v61
    v_exp_f32 v62, v62
    v_exp_f32 v63, v63
    v_exp_f32 v64, v64
    v_exp_f32 v65, v65
    v_smfmac_f32_32x32x32_bf16 v[224:239], v[112:115], v[56:63], v3
    v_exp_f32 v66, v66
    v_exp_f32 v67, v67
    s_waitcnt vmcnt(0)
    v_exp_f32 v68, v68
    v_mfma_f32_32x32x16_bf16 v[48:63], v[116:119], v[16:19], 0
    v_exp_f32 v69, v69
    v_exp_f32 v70, v70
    v_exp_f32 v71, v71
    v_exp_f32 v72, v72
    v_exp_f32 v73, v73
    v_exp_f32 v74, v74
    v_smfmac_f32_32x32x32_bf16 v[240:255], v[108:111], v[64:71], v3
    v_exp_f32 v75, v75
    v_exp_f32 v76, v76
    v_exp_f32 v77, v77
    v_exp_f32 v78, v78
    v_exp_f32 v79, v79
    v_exp_f32 v48, v48
    v_exp_f32 v49, v49
    v_smfmac_f32_32x32x32_bf16 v[240:255], v[112:115], v[72:79], v3
    v_exp_f32 v50, v50
    v_exp_f32 v51, v51
    v_exp_f32 v52, v52
    v_mfma_f32_32x32x16_bf16 v[64:79], v[116:119], v[20:23], 0
    v_exp_f32 v53, v53
    v_exp_f32 v54, v54
    ds_read_b32 v10, v9 offset:48
    v_exp_f32 v55, v55
    v_exp_f32 v56, v56
    v_exp_f32 v57, v57
    v_exp_f32 v58, v58
    v_smfmac_f32_32x32x32_bf16 v[128:143], v[120:123], v[48:55], v3
    v_exp_f32 v59, v59
    v_exp_f32 v60, v60
    v_exp_f32 v61, v61
    v_exp_f32 v62, v62
    v_exp_f32 v63, v63
    v_exp_f32 v64, v64
    v_exp_f32 v65, v65
    v_smfmac_f32_32x32x32_bf16 v[128:143], v[124:127], v[56:63], v3
    v_exp_f32 v66, v66
    v_exp_f32 v67, v67
    v_exp_f32 v68, v68
    v_mfma_f32_32x32x16_bf16 v[48:63], v[116:119], v[24:27], 0
    v_exp_f32 v69, v69
    v_exp_f32 v70, v70
    v_exp_f32 v71, v71
    v_exp_f32 v72, v72
    v_exp_f32 v73, v73
    v_exp_f32 v74, v74
    v_smfmac_f32_32x32x32_bf16 v[144:159], v[120:123], v[64:71], v3
    v_exp_f32 v75, v75
    v_exp_f32 v76, v76
    v_exp_f32 v77, v77
    s_waitcnt lgkmcnt(0)
    v_readfirstlane_b32 s9, v10
    s_cmp_ge_u32 s9, 4
    s_cbranch_scc0 L_ckr_15
L_cko_16:
    v_exp_f32 v78, v78
    v_exp_f32 v79, v79
    v_exp_f32 v48, v48
    v_exp_f32 v49, v49
    v_smfmac_f32_32x32x32_bf16 v[144:159], v[124:127], v[72:79], v3
    v_exp_f32 v50, v50
    ds_write_b128 v12, v[128:131] offset:0
    v_exp_f32 v51, v51
    v_exp_f32 v52, v52
    v_mfma_f32_32x32x16_bf16 v[64:79], v[116:119], v[28:31], 0
    v_exp_f32 v53, v53
    v_exp_f32 v54, v54
    ds_write_b128 v12, v[132:135] offset:1024
    v_exp_f32 v55, v55
    v_exp_f32 v56, v56
    v_exp_f32 v57, v57
    v_exp_f32 v58, v58
    v_smfmac_f32_32x32x32_bf16 v[160:175], v[120:123], v[48:55], v3
    v_exp_f32 v59, v59
    v_exp_f32 v60, v60
    ds_write_b32 v13, v136 offset:2048
    v_exp_f32 v61, v61
    v_exp_f32 v62, v62
    v_exp_f32 v63, v63
    v_exp_f32 v64, v64
    v_exp_f32 v65, v65
    v_smfmac_f32_32x32x32_bf16 v[160:175], v[124:127], v[56:63], v3
    v_exp_f32 v66, v66
    ds_write_b128 v12, v[144:147] offset:2304
    v_exp_f32 v67, v67
    v_exp_f32 v68, v68
    v_mfma_f32_32x32x16_bf16 v[48:63], v[116:119], v[32:35], 0
    v_exp_f32 v69, v69
    v_exp_f32 v70, v70
    ds_write_b128 v12, v[148:151] offset:3328
    v_exp_f32 v71, v71
    v_exp_f32 v72, v72
    v_exp_f32 v73, v73
    v_exp_f32 v74, v74
    v_smfmac_f32_32x32x32_bf16 v[176:191], v[120:123], v[64:71], v3
    v_exp_f32 v75, v75
    v_exp_f32 v76, v76
    ds_write_b32 v13, v152 offset:4352
    v_exp_f32 v77, v77
    v_exp_f32 v78, v78
    v_exp_f32 v79, v79
    v_exp_f32 v48, v48
    v_exp_f32 v49, v49
    v_smfmac_f32_32x32x32_bf16 v[176:191], v[124:127], v[72:79], v3
    v_exp_f32 v50, v50
    ds_write_b128 v12, v[160:163] offset:4608
    v_exp_f32 v51, v51
    v_exp_f32 v52, v52
    v_mfma_f32_32x32x16_bf16 v[64:79], v[116:119], v[36:39], 0
    v_exp_f32 v53, v53
    v_exp_f32 v54, v54
    ds_write_b128 v12, v[164:167] offset:5632
    v_exp_f32 v55, v55
    v_exp_f32 v56, v56
    v_exp_f32 v57, v57
    v_exp_f32 v58, v58
    v_smfmac_f32_32x32x32_bf16 v[192:207], v[120:123], v[48:55], v3
    v_exp_f32 v59, v59
    v_exp_f32 v60, v60
    ds_write_b32 v13, v168 offset:6656
    v_exp_f32 v61, v61
    v_exp_f32 v62, v62
    v_exp_f32 v63, v63
    v_exp_f32 v64, v64
    v_exp_f32 v65, v65
    v_smfmac_f32_32x32x32_bf16 v[192:207], v[124:127], v[56:63], v3
    v_exp_f32 v66, v66
    ds_write_b128 v12, v[176:179] offset:6912
    v_exp_f32 v67, v67
    v_exp_f32 v68, v68
    v_mfma_f32_32x32x16_bf16 v[48:63], v[116:119], v[40:43], 0
    v_exp_f32 v69, v69
    v_exp_f32 v70, v70
    ds_write_b128 v12, v[180:183] offset:7936
    v_exp_f32 v71, v71
    v_exp_f32 v72, v72
    v_exp_f32 v73, v73
    v_exp_f32 v74, v74
    v_smfmac_f32_32x32x32_bf16 v[208:223], v[120:123], v[64:71], v3
    v_exp_f32 v75, v75
    v_exp_f32 v76, v76
    ds_write_b32 v13, v184 offset:8960
    v_exp_f32 v77, v77
    v_exp_f32 v78, v78
    v_exp_f32 v79, v79
    v_exp_f32 v48, v48
    v_exp_f32 v49, v49
    v_smfmac_f32_32x32x32_bf16 v[208:223], v[124:127], v[72:79], v3
    v_exp_f32 v50, v50
    ds_write_b128 v12, v[192:195] offset:9216
    v_exp_f32 v51, v51
    v_exp_f32 v52, v52
    v_mfma_f32_32x32x16_bf16 v[64:79], v[116:119], v[44:47], 0
    v_exp_f32 v53, v53
    v_exp_f32 v54, v54
    ds_write_b128 v12, v[196:199] offset:10240
    v_exp_f32 v55, v55
    v_exp_f32 v56, v56
    v_exp_f32 v57, v57
    v_exp_f32 v58, v58
    v_smfmac_f32_32x32x32_bf16 v[224:239], v[120:123], v[48:55], v3
    v_exp_f32 v59, v59
    v_exp_f32 v60, v60
    ds_write_b32 v13, v200 offset:11264
    v_exp_f32 v61, v61
    v_exp_f32 v62, v62
    v_exp_f32 v63, v63
    v_exp_f32 v64, v64
    v_exp_f32 v65, v65
    v_smfmac_f32_32x32x32_bf16 v[224:239], v[124:127], v[56:63], v3
    v_exp_f32 v66, v66
    ds_write_b128 v12, v[208:211] offset:11520
    v_exp_f32 v67, v67
    v_exp_f32 v68, v68
    ds_write_b128 v12, v[212:215] offset:12544
    v_exp_f32 v69, v69
    v_exp_f32 v70, v70
    v_exp_f32 v71, v71
    ds_write_b32 v13, v216 offset:13568
    v_exp_f32 v72, v72
    v_exp_f32 v73, v73
    s_mov_b64 exec, 1
    ds_add_u32 v9, v2 offset:112
    s_mov_b64 exec, -1
    v_exp_f32 v74, v74
    v_smfmac_f32_32x32x32_bf16 v[240:255], v[120:123], v[64:71], v3
    v_exp_f32 v75, v75
    v_exp_f32 v76, v76
    v_exp_f32 v77, v77
    v_exp_f32 v78, v78
    v_exp_f32 v79, v79
    s_setprio 3
    s_nop 0
    v_smfmac_f32_32x32x32_bf16 v[240:255], v[124:127], v[72:79], v3
L_sp_17:
    ds_read_b32 v1, v9 offset:112
    s_sub_u32 s10, s10, 1
    s_cmp_lt_i32 s10, 0
    s_cbranch_scc1 L_spd_18
    s_waitcnt lgkmcnt(0)
    v_readfirstlane_b32 s9, v1
    s_cmp_lt_u32 s9, 4
    s_cbranch_scc1 L_sp_17
L_spd_18:
    ds_read2st64_b32 v[152:153], v7 offset0:8 offset1:17
    ds_read2st64_b32 v[154:155], v14 offset0:8 offset1:17
    ds_read2st64_b32 v[156:157], v15 offset0:8 offset1:17
    ds_read_b128 v[128:131], v4 offset:0
    ds_read_b128 v[132:135], v4 offset:1024
    ds_read_b128 v[136:139], v5 offset:0
    ds_read_b128 v[140:143], v5 offset:1024
    ds_read_b128 v[144:147], v6 offset:0
    ds_read_b128 v[148:151], v6 offset:1024
    ds_read_b128 v[160:163], v4 offset:2304
    ds_read_b128 v[164:167], v4 offset:3328
    ds_read_b128 v[168:171], v5 offset:2304
    ds_read_b128 v[172:175], v5 offset:3328
    ds_read_b128 v[176:179], v6 offset:2304
    ds_read_b128 v[180:183], v6 offset:3328
    s_waitcnt lgkmcnt(12)
    v_pk_add_f32 v[152:153], v[152:153], v[154:155]
    v_pk_add_f32 v[152:153], v[152:153], v[156:157]
    v_add_f32 v232, v232, v152
    v_subrev_u32 v233, s21, v232
    v_cmp_le_u32 vcc, s22, v233
    v_rcp_f32 v232, v232
    s_waitcnt lgkmcnt(8)
    v_pk_add_f32 v[224:225], v[224:225], v[128:129]
    v_pk_add_f32 v[226:227], v[226:227], v[130:131]
    v_pk_add_f32 v[228:229], v[228:229], v[132:133]
    v_pk_add_f32 v[230:231], v[230:231], v[134:135]
    v_pk_add_f32 v[224:225], v[224:225], v[136:137]
    v_pk_add_f32 v[226:227], v[226:227], v[138:139]
    v_pk_add_f32 v[228:229], v[228:229], v[140:141]
    v_pk_add_f32 v[230:231], v[230:231], v[142:143]
    s_waitcnt lgkmcnt(6)
    v_pk_add_f32 v[224:225], v[224:225], v[144:145]
    v_pk_add_f32 v[226:227], v[226:227], v[146:147]
    v_pk_add_f32 v[228:229], v[228:229], v[148:149]
    v_pk_add_f32 v[230:231], v[230:231], v[150:151]
    s_cbranch_vccnz L_slow0
L_norm0:
    v_pk_mul_f32 v[224:225], v[224:225], v[232:233] op_sel_hi:[1,0]
    v_pk_mul_f32 v[226:227], v[226:227], v[232:233] op_sel_hi:[1,0]
    v_pk_mul_f32 v[228:229], v[228:229], v[232:233] op_sel_hi:[1,0]
    v_pk_mul_f32 v[230:231], v[230:231], v[232:233] op_sel_hi:[1,0]
    v_cvt_pk_bf16_f32 v236, v224, v225
    v_cvt_pk_bf16_f32 v237, v226, v227
    v_cvt_pk_bf16_f32 v238, v228, v229
    v_cvt_pk_bf16_f32 v239, v230, v231
    v_min_u32 v236, 0xfffffffe, v236
    buffer_store_dwordx4 v[236:239], v8, s[64:67], s7 offen offset:0 sc1
    v_add_f32 v248, v248, v153
    v_subrev_u32 v249, s21, v248
    v_cmp_le_u32 vcc, s22, v249
    v_rcp_f32 v248, v248
    s_waitcnt lgkmcnt(0)
    v_pk_add_f32 v[240:241], v[240:241], v[160:161]
    v_pk_add_f32 v[242:243], v[242:243], v[162:163]
    v_pk_add_f32 v[244:245], v[244:245], v[164:165]
    v_pk_add_f32 v[246:247], v[246:247], v[166:167]
    v_pk_add_f32 v[240:241], v[240:241], v[168:169]
    v_pk_add_f32 v[242:243], v[242:243], v[170:171]
    v_pk_add_f32 v[244:245], v[244:245], v[172:173]
    v_pk_add_f32 v[246:247], v[246:247], v[174:175]
    v_pk_add_f32 v[240:241], v[240:241], v[176:177]
    v_pk_add_f32 v[242:243], v[242:243], v[178:179]
    v_pk_add_f32 v[244:245], v[244:245], v[180:181]
    v_pk_add_f32 v[246:247], v[246:247], v[182:183]
    s_cbranch_vccnz L_slow1
L_norm1:
    v_pk_mul_f32 v[240:241], v[240:241], v[248:249] op_sel_hi:[1,0]
    v_pk_mul_f32 v[242:243], v[242:243], v[248:249] op_sel_hi:[1,0]
    v_pk_mul_f32 v[244:245], v[244:245], v[248:249] op_sel_hi:[1,0]
    v_pk_mul_f32 v[246:247], v[246:247], v[248:249] op_sel_hi:[1,0]
    v_cvt_pk_bf16_f32 v252, v240, v241
    v_cvt_pk_bf16_f32 v253, v242, v243
    v_cvt_pk_bf16_f32 v254, v244, v245
    v_cvt_pk_bf16_f32 v255, v246, v247
    v_min_u32 v252, 0xfffffffe, v252
    buffer_store_dwordx4 v[252:255], v8, s[64:67], s7 offen offset:1024 sc1
    s_mov_b64 exec, 1
    ds_add_u32 v9, v2 offset:120
    s_mov_b64 exec, -1
    s_mov_b32 s62, 2097152
    s_mov_b32 s63, 0x00020000
    v_lshrrev_b32 v118, 3, v0
    s_lshl2_add_u32 s9, s11, s12
    s_lshl3_add_u32 s9, s9, 0
    v_add_u32 v118, s9, v118
    v_mul_u32_u24 v116, 272, v118
    v_lshlrev_b32 v117, 10, v118
    v_and_b32 v118, 7, v0
    v_lshl_add_u32 v116, v118, 5, v116
    v_add_u32 v116, 107520, v116
    v_lshl_add_u32 v117, v118, 4, v117
    s_lshl_b32 s20, s27, 16
    s_lshl_b32 s9, s3, 7
    s_add_u32 s20, s20, s9
    buffer_load_dwordx4 v[112:115], v117, s[28:31], s20 offen
    s_waitcnt vmcnt(1)
    s_barrier
    s_waitcnt vmcnt(0)
    v_lshlrev_b32 v120, 16, v112
    v_and_b32 v121, 0xffff0000, v112
    v_lshlrev_b32 v122, 16, v113
    v_and_b32 v123, 0xffff0000, v113
    v_lshlrev_b32 v124, 16, v114
    v_and_b32 v125, 0xffff0000, v114
    v_lshlrev_b32 v126, 16, v115
    v_and_b32 v127, 0xffff0000, v115
    s_setprio 0
    s_branch L_spf_22
L_sp_20:
    s_sleep 1
L_spf_22:
    ds_read_b32 v1, v9 offset:124
    s_sub_u32 s10, s10, 1
    s_cmp_lt_i32 s10, 0
    s_cbranch_scc1 L_spd_21
    s_waitcnt lgkmcnt(0)
    v_readfirstlane_b32 s9, v1
    s_cmp_lt_u32 s9, 4
    s_cbranch_scc1 L_sp_20
L_spd_21:
    ds_read_b128 v[48:51], v116 offset:0
    ds_read_b128 v[56:59], v116 offset:17408
    ds_read_b128 v[52:55], v116 offset:16
    ds_read_b128 v[60:63], v116 offset:17424
    s_waitcnt lgkmcnt(3)
    v_pk_add_f32 v[120:121], v[120:121], v[48:49]
    v_pk_add_f32 v[122:123], v[122:123], v[50:51]
    s_waitcnt lgkmcnt(2)
    v_pk_add_f32 v[120:121], v[120:121], v[56:57]
    v_pk_add_f32 v[122:123], v[122:123], v[58:59]
    v_cvt_pk_bf16_f32 v64, v120, v121
    v_cvt_pk_bf16_f32 v65, v122, v123
    s_waitcnt lgkmcnt(1)
    v_pk_add_f32 v[124:125], v[124:125], v[52:53]
    v_pk_add_f32 v[126:127], v[126:127], v[54:55]
    s_waitcnt lgkmcnt(0)
    v_pk_add_f32 v[124:125], v[124:125], v[60:61]
    v_pk_add_f32 v[126:127], v[126:127], v[62:63]
    v_cvt_pk_bf16_f32 v66, v124, v125
    v_cvt_pk_bf16_f32 v67, v126, v127
    buffer_store_dwordx4 v[64:67], v117, s[60:63], s20 offen sc1
    s_endpgm
L_ckr_4:
    ds_read_b32 v1, v81 offset:80
    s_waitcnt lgkmcnt(0)
    s_sub_u32 s10, s10, 1
    s_cmp_lt_i32 s10, 0
    s_cbranch_scc1 L_cko_5
    v_readfirstlane_b32 s9, v1
    s_cmp_ge_u32 s9, 1
    s_cbranch_scc0 L_ckr_4
    s_branch L_cko_5
L_kvr_6:
    s_sleep 2
    s_mov_b64 exec, 0xff
    buffer_load_dword v119, v107, s[64:67], s20 offen sc1
    s_mov_b64 exec, -1
    s_waitcnt vmcnt(0)
    s_sub_u32 s10, s10, 1
    s_cmp_lt_i32 s10, 0
    s_cbranch_scc1 L_kvo_7
    v_cmp_eq_u32 vcc, s25, v119
    s_and_b32 s9, vcc_lo, 0xff
    s_cmp_eq_u32 s9, 0xff
    s_cbranch_scc0 L_kvr_6
    s_branch L_kvo_7
L_ckr_11:
    ds_read_b32 v10, v9 offset:8
    s_waitcnt lgkmcnt(0)
    s_sub_u32 s10, s10, 1
    s_cmp_lt_i32 s10, 0
    s_cbranch_scc1 L_cko_12
    v_readfirstlane_b32 s9, v10
    s_cmp_ge_u32 s9, 4
    s_cbranch_scc0 L_ckr_11
    s_branch L_cko_12
L_kvr_13:
    s_sleep 2
    buffer_load_dword v119, v107, s[64:67], s20 offen sc1
    s_waitcnt vmcnt(0)
    s_sub_u32 s10, s10, 1
    s_cmp_lt_i32 s10, 0
    s_cbranch_scc1 L_kvo_14
    v_cmp_eq_u32 vcc, s25, v119
    s_cmp_eq_u64 vcc, exec
    s_cbranch_scc0 L_kvr_13
    s_branch L_kvo_14
L_ckr_15:
    ds_read_b32 v10, v9 offset:48
    s_waitcnt lgkmcnt(0)
    s_sub_u32 s10, s10, 1
    s_cmp_lt_i32 s10, 0
    s_cbranch_scc1 L_cko_16
    v_readfirstlane_b32 s9, v10
    s_cmp_ge_u32 s9, 4
    s_cbranch_scc0 L_ckr_15
    s_branch L_cko_16
    .p2align 12
L_gcont:
    s_cbranch_execz L_rt0
    v_and_b32 v4, 15, v0
    v_lshrrev_b32 v5, 4, v0
    s_bfe_u32 s9, s3, 0x10001
    s_lshl_b32 s4, s9, 4
    v_add_u32 v6, s4, v4
    s_lshr_b32 s21, s3, 2
    s_add_u32 s5, s13, 8192
    v_xor_b32 v7, v4, v5
    v_lshlrev_b32 v7, 4, v7
    v_lshl_add_u32 v7, v5, 8, v7
    v_add_u32 v96, s5, v7
    v_xor_b32 v97, 64, v96
    v_add_u32 v97, 1024, v97
    v_and_b32 v7, 1, v5
    v_lshlrev_b32 v98, 3, v4
    v_lshl_add_u32 v98, v5, 8, v98
    v_lshl_add_u32 v98, v7, 7, v98
    v_add_u32 v98, s13, v98
    v_xor_b32 v99, 128, v98
    v_lshrrev_b32 v5, 1, v5
    v_lshl_add_u32 v100, v7, 5, v6
    v_lshlrev_b32 v100, 4, v100
    v_lshl_add_u32 v100, v5, 3, v100
    v_lshl_add_u32 v101, v5, 4, v4
    v_lshlrev_b32 v101, 4, v101
    v_lshl_add_u32 v101, v7, 3, v101
    s_lshl_b32 s4, s9, 9
    s_add_u32 s4, s4, 1024
    v_add_u32 v101, s4, v101
    s_and_b32 s4, s3, 1
    s_cselect_b64 vcc, -1, 0
    s_cselect_b32 s25, 0xbf317218, 0
    s_cselect_b32 s4, 0, 0x3e317218
    s_or_b32 s25, s25, s4
    v_cndmask_b32 v100, v100, v101, vcc
    v_add_u32 v102, 156672, v8
    s_lshl_b32 s4, s18, 10
    v_add_u32 v101, s4, v102
    s_lshl_b32 s8, s27, 1
    s_add_u32 s21, s21, s8
    s_lshl_b32 s8, s21, 11
    s_lshl_b32 s21, s21, 7
    s_and_b32 s4, s3, 3
    s_lshl_b32 s4, s4, 2
    s_add_u32 s21, s21, s4
    s_add_u32 s21, s21, 9388032
    s_lshl_b32 s4, s18, 2
    v_add_u32 v112, s4, v9
    s_and_b32 s5, s3, 1
    s_xor_b32 s4, s5, s26
    s_lshl_b32 s4, s4, 3
    v_lshrrev_b32 v4, 3, v0
    v_add_u32 v4, s4, v4
    v_lshl_add_u32 v72, v4, 3, v9
    v_lshl_add_u32 v73, v4, 2, v9
    v_and_b32 v5, 7, v0
    v_xor_b32 v4, v4, v5
    v_lshlrev_b32 v4, 4, v4
    v_lshl_add_u32 v4, v5, 8, v4
    s_mul_i32 s5, s5, 24576
    s_add_u32 s4, s5, 115712
    v_add_u32 v76, s4, v4
    s_sub_u32 s4, 140288, s5
    v_add_u32 v77, s4, v4
    v_and_b32 v4, 15, v0
    v_lshl_add_u32 v74, v4, 3, v9
    v_bfe_u32 v5, v0, 4, 2
    v_lshlrev_b32 v5, 2, v5
    v_cndmask_b32 v4, v4, v5, vcc
    v_lshl_add_u32 v75, v4, 2, v9
    v_mov_b32 v64, 0
    v_mov_b32 v65, 0
    v_mov_b32 v66, 0
    v_mov_b32 v67, 0
    v_mov_b32 v160, 0
    v_mov_b32 v161, 0
    v_mov_b32 v166, 0
    v_mov_b32 v167, 0
    v_mov_b32 v170, 0
    v_mov_b32 v171, 0
    v_lshrrev_b32 v4, 2, v0
    v_and_b32 v5, 3, v0
    v_lshlrev_b32 v103, 10, v4
    v_lshl_add_u32 v103, v5, 4, v103
    s_lshl_b32 s23, s11, 18
    s_lshl_b32 s4, s3, 7
    s_add_u32 s23, s23, s4
    s_lshl_b32 s4, s12, 6
    s_add_u32 s23, s23, s4
    s_lshl_b32 s4, s96, 14
    s_add_u32 s23, s23, s4
    s_barrier
    s_waitcnt vmcnt(9)
    ds_read_b64_tr_b16 v[128:129], v98 offset:0
    ds_read_b64_tr_b16 v[130:131], v99 offset:0
    ds_read_b64_tr_b16 v[132:133], v98 offset:1024
    ds_read_b64_tr_b16 v[134:135], v99 offset:1024
    ds_read_b64_tr_b16 v[136:137], v98 offset:2048
    ds_read_b64_tr_b16 v[138:139], v99 offset:2048
    ds_read_b64_tr_b16 v[140:141], v98 offset:3072
    ds_read_b64_tr_b16 v[142:143], v99 offset:3072
    s_cmp_lg_u32 s11, 0
    s_cbranch_scc1 L_nown_23
    s_waitcnt vmcnt(8)
    ds_write_b128 v76, v[16:19] offset:0
    v_dot2c_f32_bf16 v64, s19, v16
    v_dot2c_f32_bf16 v66, v16, v16
    v_dot2c_f32_bf16 v65, s19, v17
    v_dot2c_f32_bf16 v67, v17, v17
    v_dot2c_f32_bf16 v64, s19, v18
    v_dot2c_f32_bf16 v66, v18, v18
    v_dot2c_f32_bf16 v65, s19, v19
    v_dot2c_f32_bf16 v67, v19, v19
    s_waitcnt lgkmcnt(1)
    v_dot2c_f32_bf16 v160, s19, v128
    v_dot2c_f32_bf16 v161, s19, v129
    v_dot2c_f32_bf16 v160, s19, v130
    v_dot2c_f32_bf16 v161, s19, v131
    v_dot2c_f32_bf16 v160, s19, v132
    v_dot2c_f32_bf16 v161, s19, v133
    v_dot2c_f32_bf16 v160, s19, v134
    v_dot2c_f32_bf16 v161, s19, v135
    v_dot2c_f32_bf16 v160, s19, v136
    v_dot2c_f32_bf16 v161, s19, v137
    v_dot2c_f32_bf16 v160, s19, v138
    v_dot2c_f32_bf16 v161, s19, v139
    v_dot2c_f32_bf16 v160, s19, v140
    v_dot2c_f32_bf16 v161, s19, v141
    v_dot2c_f32_bf16 v160, s19, v142
    v_dot2c_f32_bf16 v161, s19, v143
    s_waitcnt vmcnt(7)
    ds_write_b128 v76, v[20:23] offset:2048
    v_dot2c_f32_bf16 v64, s19, v20
    v_dot2c_f32_bf16 v66, v20, v20
    v_dot2c_f32_bf16 v65, s19, v21
    v_dot2c_f32_bf16 v67, v21, v21
    v_dot2c_f32_bf16 v64, s19, v22
    v_dot2c_f32_bf16 v66, v22, v22
    v_dot2c_f32_bf16 v65, s19, v23
    v_dot2c_f32_bf16 v67, v23, v23
    v_add_f32 v160, v160, v161
    v_cvt_pk_bf16_f32 v161, 0, v160
    v_sub_f32 v160, v160, v161
    v_cvt_pk_bf16_f32 v162, 0, v160
    v_sub_f32 v160, v160, v162
    v_cvt_pk_bf16_f32 v164, v161, v162
    v_cvt_pk_bf16_f32 v165, v160, 0
    s_waitcnt vmcnt(6)
    ds_write_b128 v76, v[24:27] offset:12288
    v_dot2c_f32_bf16 v64, s19, v24
    v_dot2c_f32_bf16 v66, v24, v24
    v_dot2c_f32_bf16 v65, s19, v25
    v_dot2c_f32_bf16 v67, v25, v25
    v_dot2c_f32_bf16 v64, s19, v26
    v_dot2c_f32_bf16 v66, v26, v26
    v_dot2c_f32_bf16 v65, s19, v27
    v_dot2c_f32_bf16 v67, v27, v27
    s_waitcnt vmcnt(5)
    ds_write_b128 v76, v[28:31] offset:14336
    v_dot2c_f32_bf16 v64, s19, v28
    v_dot2c_f32_bf16 v66, v28, v28
    v_dot2c_f32_bf16 v65, s19, v29
    v_dot2c_f32_bf16 v67, v29, v29
    v_dot2c_f32_bf16 v64, s19, v30
    v_dot2c_f32_bf16 v66, v30, v30
    v_dot2c_f32_bf16 v65, s19, v31
    v_dot2c_f32_bf16 v67, v31, v31
    s_waitcnt vmcnt(4)
    ds_write_b128 v77, v[32:35] offset:0
    v_dot2c_f32_bf16 v64, s19, v32
    v_dot2c_f32_bf16 v66, v32, v32
    v_dot2c_f32_bf16 v65, s19, v33
    v_dot2c_f32_bf16 v67, v33, v33
    v_dot2c_f32_bf16 v64, s19, v34
    v_dot2c_f32_bf16 v66, v34, v34
    v_dot2c_f32_bf16 v65, s19, v35
    v_dot2c_f32_bf16 v67, v35, v35
    s_waitcnt vmcnt(3)
    ds_write_b128 v77, v[36:39] offset:2048
    v_dot2c_f32_bf16 v64, s19, v36
    v_dot2c_f32_bf16 v66, v36, v36
    v_dot2c_f32_bf16 v65, s19, v37
    v_dot2c_f32_bf16 v67, v37, v37
    v_dot2c_f32_bf16 v64, s19, v38
    v_dot2c_f32_bf16 v66, v38, v38
    v_dot2c_f32_bf16 v65, s19, v39
    v_dot2c_f32_bf16 v67, v39, v39
    s_waitcnt vmcnt(2)
    ds_write_b128 v77, v[40:43] offset:12288
    v_dot2c_f32_bf16 v64, s19, v40
    v_dot2c_f32_bf16 v66, v40, v40
    v_dot2c_f32_bf16 v65, s19, v41
    v_dot2c_f32_bf16 v67, v41, v41
    v_dot2c_f32_bf16 v64, s19, v42
    v_dot2c_f32_bf16 v66, v42, v42
    v_dot2c_f32_bf16 v65, s19, v43
    v_dot2c_f32_bf16 v67, v43, v43
    s_waitcnt vmcnt(1)
    ds_write_b128 v77, v[44:47] offset:14336
    v_dot2c_f32_bf16 v64, s19, v44
    v_dot2c_f32_bf16 v66, v44, v44
    v_dot2c_f32_bf16 v65, s19, v45
    v_dot2c_f32_bf16 v67, v45, v45
    v_dot2c_f32_bf16 v64, s19, v46
    v_dot2c_f32_bf16 v66, v46, v46
    v_dot2c_f32_bf16 v65, s19, v47
    v_dot2c_f32_bf16 v67, v47, v47
    s_branch L_sumj_24
L_nown_23:
    s_waitcnt vmcnt(8)
    v_dot2c_f32_bf16 v64, s19, v16
    v_dot2c_f32_bf16 v66, v16, v16
    v_dot2c_f32_bf16 v65, s19, v17
    v_dot2c_f32_bf16 v67, v17, v17
    v_dot2c_f32_bf16 v64, s19, v18
    v_dot2c_f32_bf16 v66, v18, v18
    v_dot2c_f32_bf16 v65, s19, v19
    v_dot2c_f32_bf16 v67, v19, v19
    s_waitcnt lgkmcnt(0)
    v_dot2c_f32_bf16 v160, s19, v128
    v_dot2c_f32_bf16 v161, s19, v129
    v_dot2c_f32_bf16 v160, s19, v130
    v_dot2c_f32_bf16 v161, s19, v131
    v_dot2c_f32_bf16 v160, s19, v132
    v_dot2c_f32_bf16 v161, s19, v133
    v_dot2c_f32_bf16 v160, s19, v134
    v_dot2c_f32_bf16 v161, s19, v135
    v_dot2c_f32_bf16 v160, s19, v136
    v_dot2c_f32_bf16 v161, s19, v137
    v_dot2c_f32_bf16 v160, s19, v138
    v_dot2c_f32_bf16 v161, s19, v139
    v_dot2c_f32_bf16 v160, s19, v140
    v_dot2c_f32_bf16 v161, s19, v141
    v_dot2c_f32_bf16 v160, s19, v142
    v_dot2c_f32_bf16 v161, s19, v143
    s_waitcnt vmcnt(7)
    v_dot2c_f32_bf16 v64, s19, v20
    v_dot2c_f32_bf16 v66, v20, v20
    v_dot2c_f32_bf16 v65, s19, v21
    v_dot2c_f32_bf16 v67, v21, v21
    v_dot2c_f32_bf16 v64, s19, v22
    v_dot2c_f32_bf16 v66, v22, v22
    v_dot2c_f32_bf16 v65, s19, v23
    v_dot2c_f32_bf16 v67, v23, v23
    v_add_f32 v160, v160, v161
    v_cvt_pk_bf16_f32 v161, 0, v160
    v_sub_f32 v160, v160, v161
    v_cvt_pk_bf16_f32 v162, 0, v160
    v_sub_f32 v160, v160, v162
    v_cvt_pk_bf16_f32 v164, v161, v162
    v_cvt_pk_bf16_f32 v165, v160, 0
    s_waitcnt vmcnt(6)
    v_dot2c_f32_bf16 v64, s19, v24
    v_dot2c_f32_bf16 v66, v24, v24
    v_dot2c_f32_bf16 v65, s19, v25
    v_dot2c_f32_bf16 v67, v25, v25
    v_dot2c_f32_bf16 v64, s19, v26
    v_dot2c_f32_bf16 v66, v26, v26
    v_dot2c_f32_bf16 v65, s19, v27
    v_dot2c_f32_bf16 v67, v27, v27
    s_waitcnt vmcnt(5)
    v_dot2c_f32_bf16 v64, s19, v28
    v_dot2c_f32_bf16 v66, v28, v28
    v_dot2c_f32_bf16 v65, s19, v29
    v_dot2c_f32_bf16 v67, v29, v29
    v_dot2c_f32_bf16 v64, s19, v30
    v_dot2c_f32_bf16 v66, v30, v30
    v_dot2c_f32_bf16 v65, s19, v31
    v_dot2c_f32_bf16 v67, v31, v31
    s_waitcnt vmcnt(4)
    v_dot2c_f32_bf16 v64, s19, v32
    v_dot2c_f32_bf16 v66, v32, v32
    v_dot2c_f32_bf16 v65, s19, v33
    v_dot2c_f32_bf16 v67, v33, v33
    v_dot2c_f32_bf16 v64, s19, v34
    v_dot2c_f32_bf16 v66, v34, v34
    v_dot2c_f32_bf16 v65, s19, v35
    v_dot2c_f32_bf16 v67, v35, v35
    s_waitcnt vmcnt(3)
    v_dot2c_f32_bf16 v64, s19, v36
    v_dot2c_f32_bf16 v66, v36, v36
    v_dot2c_f32_bf16 v65, s19, v37
    v_dot2c_f32_bf16 v67, v37, v37
    v_dot2c_f32_bf16 v64, s19, v38
    v_dot2c_f32_bf16 v66, v38, v38
    v_dot2c_f32_bf16 v65, s19, v39
    v_dot2c_f32_bf16 v67, v39, v39
    s_waitcnt vmcnt(2)
    v_dot2c_f32_bf16 v64, s19, v40
    v_dot2c_f32_bf16 v66, v40, v40
    v_dot2c_f32_bf16 v65, s19, v41
    v_dot2c_f32_bf16 v67, v41, v41
    v_dot2c_f32_bf16 v64, s19, v42
    v_dot2c_f32_bf16 v66, v42, v42
    v_dot2c_f32_bf16 v65, s19, v43
    v_dot2c_f32_bf16 v67, v43, v43
    s_waitcnt vmcnt(1)
    v_dot2c_f32_bf16 v64, s19, v44
    v_dot2c_f32_bf16 v66, v44, v44
    v_dot2c_f32_bf16 v65, s19, v45
    v_dot2c_f32_bf16 v67, v45, v45
    v_dot2c_f32_bf16 v64, s19, v46
    v_dot2c_f32_bf16 v66, v46, v46
    v_dot2c_f32_bf16 v65, s19, v47
    v_dot2c_f32_bf16 v67, v47, v47
L_sumj_24:
    s_nop 2
    v_add_f32 v64, v64, v65
    v_add_f32 v66, v66, v67
    s_nop 0
    v_add_f32_dpp v64, v64, v64 quad_perm:[1,0,3,2] row_mask:0xf bank_mask:0xf
    v_add_f32_dpp v66, v66, v66 quad_perm:[1,0,3,2] row_mask:0xf bank_mask:0xf
    s_nop 0
    v_add_f32_dpp v64, v64, v64 quad_perm:[2,3,0,1] row_mask:0xf bank_mask:0xf
    v_add_f32_dpp v66, v66, v66 quad_perm:[2,3,0,1] row_mask:0xf bank_mask:0xf
    s_nop 0
    v_add_f32_dpp v64, v64, v64 row_half_mirror row_mask:0xf bank_mask:0xf
    v_add_f32_dpp v66, v66, v66 row_half_mirror row_mask:0xf bank_mask:0xf
    v_mul_f32 v64, 0xbb000000, v64
    v_mul_f32 v66, 0x3b000000, v66
    v_fma_f32 v66, -v64, v64, v66
    v_max_f32 v66, 0, v66
    v_cvt_pk_bf16_f32 v66, 0, v66
    v_add_f32 v66, 0x3727c5ac, v66
    v_cvt_pk_bf16_f32 v66, 0, v66
    v_sqrt_f32 v66, v66
    v_cvt_pk_bf16_f32 v65, v64, v64
    v_cvt_pk_bf16_f32 v66, 0, v66
    v_rcp_f32 v66, v66
    v_and_b32 v64, 0xffff0000, v65
    v_mul_f32 v66, 0xbfb8aa3b, v66
    s_waitcnt vmcnt(0)
    s_mov_b32 exec_lo, 0x01010101
    s_mov_b32 exec_hi, 0x01010101
    ds_write2_b32 v72, v65, v65 offset0:64 offset1:65
    ds_write_b32 v73, v66 offset:512
    s_mov_b64 exec, 1
    s_cmp_eq_u32 s26, 0
    s_cselect_b32 s98, 0x9e3779b9, 0
    v_add_u32 v71, s98, v71
    v_sub_u32 v1, 1, s11
    ds_add_u32 v9, v71 offset:64
    ds_add_u32 v9, v1 offset:60
    s_mov_b64 exec, -1
L_sp_25:
    ds_read_b32 v1, v9 offset:60
    s_sub_u32 s10, s10, 1
    s_cmp_lt_i32 s10, 0
    s_cbranch_scc1 L_spd_26
    s_waitcnt lgkmcnt(0)
    v_readfirstlane_b32 s9, v1
    s_cmp_lt_u32 s9, 2
    s_cbranch_scc1 L_sp_25
L_spd_26:
    ds_read_b128 v[144:147], v96 offset:0
    ds_read_b128 v[148:151], v97 offset:0
    ds_read_b128 v[152:155], v96 offset:2048
    ds_read_b128 v[156:159], v97 offset:2048
    ds_read_b64 v[168:169], v74 offset:256
    ds_read_b32 v15, v9 offset:64
    s_bitcmp1_b32 s3, 0
    s_cbranch_scc1 L_jv_28
    ds_read2_b32 v[172:173], v75 offset0:128 offset1:128
    ds_read2_b32 v[174:175], v75 offset0:128 offset1:128
    s_waitcnt lgkmcnt(7)
    v_mfma_f32_16x16x32_bf16 v[160:163], v[128:131], v[144:147], 0
    s_waitcnt lgkmcnt(6)
    v_mfma_f32_16x16x32_bf16 v[160:163], v[132:135], v[148:151], v[160:163]
    s_waitcnt lgkmcnt(5)
    v_mfma_f32_16x16x32_bf16 v[160:163], v[136:139], v[152:155], v[160:163]
    s_waitcnt lgkmcnt(4)
    v_mfma_f32_16x16x32_bf16 v[160:163], v[140:143], v[156:159], v[160:163]
    s_waitcnt lgkmcnt(3)
    v_mfma_f32_16x16x32_bf16 v[160:163], v[164:167], v[168:171], v[160:163]
    s_branch L_jj_29
L_jv_28:
    ds_read_b128 v[172:175], v75 offset:512
    s_waitcnt lgkmcnt(6)
    v_mfma_f32_16x16x32_bf16 v[160:163], v[144:147], v[128:131], 0
    s_waitcnt lgkmcnt(5)
    v_mfma_f32_16x16x32_bf16 v[160:163], v[148:151], v[132:135], v[160:163]
    s_waitcnt lgkmcnt(4)
    v_mfma_f32_16x16x32_bf16 v[160:163], v[152:155], v[136:139], v[160:163]
    s_waitcnt lgkmcnt(3)
    v_mfma_f32_16x16x32_bf16 v[160:163], v[156:159], v[140:143], v[160:163]
    s_waitcnt lgkmcnt(2)
    v_mfma_f32_16x16x32_bf16 v[160:163], v[168:171], v[164:167], v[160:163]
L_jj_29:
    s_nop 7
    ds_write_b128 v101, v[160:163]
    s_mov_b64 exec, 1
    ds_add_rtn_u32 v1, v9, v2 offset:56
    s_mov_b64 exec, -1
    s_waitcnt lgkmcnt(0)
    v_readfirstlane_b32 s22, v1
    s_cmp_eq_u32 s22, 3
    s_cselect_b32 s21, s21, 2147418112
    s_cbranch_scc0 L_kvnl_30
    ds_read_b128 v[144:147], v102 offset:0
    ds_read_b128 v[148:151], v102 offset:1024
    ds_read_b128 v[152:155], v102 offset:2048
    ds_read_b128 v[156:159], v102 offset:3072
    v_mul_f32 v172, s25, v172
    v_mul_f32 v173, s25, v173
    v_mul_f32 v174, s25, v174
    v_mul_f32 v175, s25, v175
    s_waitcnt lgkmcnt(2)
    v_pk_add_f32 v[144:145], v[144:145], v[148:149]
    v_pk_add_f32 v[146:147], v[146:147], v[150:151]
    s_waitcnt lgkmcnt(0)
    v_pk_add_f32 v[152:153], v[152:153], v[156:157]
    v_pk_add_f32 v[154:155], v[154:155], v[158:159]
    v_pk_add_f32 v[144:145], v[144:145], v[152:153]
    v_pk_add_f32 v[146:147], v[146:147], v[154:155]
    v_pk_mul_f32 v[144:145], v[144:145], v[172:173]
    v_pk_mul_f32 v[146:147], v[146:147], v[174:175]
    v_cvt_pk_bf16_f32 v160, v144, v145
    v_cvt_pk_bf16_f32 v161, v146, v147
    buffer_store_dwordx2 v[160:161], v100, s[64:67], s8 offen sc1
L_kvnl_30:
    v_cvt_pk_bf16_f32 v67, 0, v66
    v_cvt_pk_bf16_f32 v66, v66, 0
    v_mul_f32 v64, v64, v67
    v_dot2_f32_bf16 v48, v16, v66, v64
    v_dot2_f32_bf16 v49, v16, v67, v64
    v_dot2_f32_bf16 v50, v17, v66, v64
    v_dot2_f32_bf16 v51, v17, v67, v64
    v_dot2_f32_bf16 v52, v18, v66, v64
    v_dot2_f32_bf16 v53, v18, v67, v64
    v_dot2_f32_bf16 v54, v19, v66, v64
    v_dot2_f32_bf16 v55, v19, v67, v64
    v_dot2_f32_bf16 v56, v20, v66, v64
    v_dot2_f32_bf16 v57, v20, v67, v64
    v_dot2_f32_bf16 v58, v21, v66, v64
    v_dot2_f32_bf16 v59, v21, v67, v64
    v_dot2_f32_bf16 v60, v22, v66, v64
    v_dot2_f32_bf16 v61, v22, v67, v64
    v_dot2_f32_bf16 v62, v23, v66, v64
    v_dot2_f32_bf16 v63, v23, v67, v64
    v_cvt_pk_bf16_f32 v16, v48, v49
    v_cvt_pk_bf16_f32 v17, v50, v51
    v_cvt_pk_bf16_f32 v18, v52, v53
    v_cvt_pk_bf16_f32 v19, v54, v55
    ds_write_b128 v68, v[16:19] offset:0
    v_dot2_f32_bf16 v48, v24, v66, v64
    v_dot2_f32_bf16 v49, v24, v67, v64
    v_dot2_f32_bf16 v50, v25, v66, v64
    v_dot2_f32_bf16 v51, v25, v67, v64
    v_dot2_f32_bf16 v52, v26, v66, v64
    v_dot2_f32_bf16 v53, v26, v67, v64
    v_dot2_f32_bf16 v54, v27, v66, v64
    v_dot2_f32_bf16 v55, v27, v67, v64
    v_cvt_pk_bf16_f32 v20, v56, v57
    v_cvt_pk_bf16_f32 v21, v58, v59
    v_cvt_pk_bf16_f32 v22, v60, v61
    v_cvt_pk_bf16_f32 v23, v62, v63
    ds_write_b128 v68, v[20:23] offset:4096
    v_dot2_f32_bf16 v56, v28, v66, v64
    v_dot2_f32_bf16 v57, v28, v67, v64
    v_dot2_f32_bf16 v58, v29, v66, v64
    v_dot2_f32_bf16 v59, v29, v67, v64
    v_dot2_f32_bf16 v60, v30, v66, v64
    v_dot2_f32_bf16 v61, v30, v67, v64
    v_dot2_f32_bf16 v62, v31, v66, v64
    v_dot2_f32_bf16 v63, v31, v67, v64
    v_cvt_pk_bf16_f32 v24, v48, v49
    v_cvt_pk_bf16_f32 v25, v50, v51
    v_cvt_pk_bf16_f32 v26, v52, v53
    v_cvt_pk_bf16_f32 v27, v54, v55
    ds_write_b128 v68, v[24:27] offset:8192
    v_dot2_f32_bf16 v48, v32, v66, v64
    v_dot2_f32_bf16 v49, v32, v67, v64
    v_dot2_f32_bf16 v50, v33, v66, v64
    v_dot2_f32_bf16 v51, v33, v67, v64
    v_dot2_f32_bf16 v52, v34, v66, v64
    v_dot2_f32_bf16 v53, v34, v67, v64
    v_dot2_f32_bf16 v54, v35, v66, v64
    v_dot2_f32_bf16 v55, v35, v67, v64
    v_cvt_pk_bf16_f32 v28, v56, v57
    v_cvt_pk_bf16_f32 v29, v58, v59
    v_cvt_pk_bf16_f32 v30, v60, v61
    v_cvt_pk_bf16_f32 v31, v62, v63
    ds_write_b128 v68, v[28:31] offset:12288
    v_xor_b32 v68, 0x4000, v68
    v_dot2_f32_bf16 v56, v36, v66, v64
    v_dot2_f32_bf16 v57, v36, v67, v64
    v_dot2_f32_bf16 v58, v37, v66, v64
    v_dot2_f32_bf16 v59, v37, v67, v64
    v_dot2_f32_bf16 v60, v38, v66, v64
    v_dot2_f32_bf16 v61, v38, v67, v64
    v_dot2_f32_bf16 v62, v39, v66, v64
    v_dot2_f32_bf16 v63, v39, v67, v64
    v_cvt_pk_bf16_f32 v32, v48, v49
    v_cvt_pk_bf16_f32 v33, v50, v51
    v_cvt_pk_bf16_f32 v34, v52, v53
    v_cvt_pk_bf16_f32 v35, v54, v55
    ds_write_b128 v68, v[32:35] offset:0
    v_dot2_f32_bf16 v48, v40, v66, v64
    v_dot2_f32_bf16 v49, v40, v67, v64
    v_dot2_f32_bf16 v50, v41, v66, v64
    v_dot2_f32_bf16 v51, v41, v67, v64
    v_dot2_f32_bf16 v52, v42, v66, v64
    v_dot2_f32_bf16 v53, v42, v67, v64
    v_dot2_f32_bf16 v54, v43, v66, v64
    v_dot2_f32_bf16 v55, v43, v67, v64
    v_cvt_pk_bf16_f32 v36, v56, v57
    v_cvt_pk_bf16_f32 v37, v58, v59
    v_cvt_pk_bf16_f32 v38, v60, v61
    v_cvt_pk_bf16_f32 v39, v62, v63
    ds_write_b128 v68, v[36:39] offset:4096
    s_waitcnt vmcnt(0)
    s_mov_b64 exec, 1
    buffer_store_dword v15, off, s[64:67], s21 sc1
    s_mov_b64 exec, -1
    v_dot2_f32_bf16 v56, v44, v66, v64
    v_dot2_f32_bf16 v57, v44, v67, v64
    v_dot2_f32_bf16 v58, v45, v66, v64
    v_dot2_f32_bf16 v59, v45, v67, v64
    v_dot2_f32_bf16 v60, v46, v66, v64
    v_dot2_f32_bf16 v61, v46, v67, v64
    v_dot2_f32_bf16 v62, v47, v66, v64
    v_dot2_f32_bf16 v63, v47, v67, v64
    v_cvt_pk_bf16_f32 v40, v48, v49
    v_cvt_pk_bf16_f32 v41, v50, v51
    v_cvt_pk_bf16_f32 v42, v52, v53
    v_cvt_pk_bf16_f32 v43, v54, v55
    ds_write_b128 v68, v[40:43] offset:8192
    v_cvt_pk_bf16_f32 v44, v56, v57
    v_cvt_pk_bf16_f32 v45, v58, v59
    v_cvt_pk_bf16_f32 v46, v60, v61
    v_cvt_pk_bf16_f32 v47, v62, v63
    ds_write_b128 v68, v[44:47] offset:12288
    s_mov_b64 exec, 1
    ds_add_u32 v9, v2 offset:116
    s_mov_b64 exec, -1
    s_add_u32 m0, s13, 0
    s_xor_b32 s15, s23, 131072
    buffer_load_dwordx4 v103, s[32:35], s15 offen lds
    s_add_u32 m0, s13, 1024
    s_xor_b32 s15, s23, 147456
    buffer_load_dwordx4 v103, s[32:35], s15 offen lds
    s_add_u32 m0, s13, 2048
    s_xor_b32 s15, s23, 163840
    buffer_load_dwordx4 v103, s[32:35], s15 offen lds
    s_add_u32 m0, s13, 3072
    s_xor_b32 s15, s23, 180224
    buffer_load_dwordx4 v103, s[32:35], s15 offen lds
    s_add_u32 m0, s13, 4096
    s_xor_b32 s15, s23, 196608
    buffer_load_dwordx4 v103, s[32:35], s15 offen lds
    s_add_u32 m0, s13, 5120
    s_xor_b32 s15, s23, 212992
    buffer_load_dwordx4 v103, s[32:35], s15 offen lds
    s_add_u32 m0, s13, 6144
    s_xor_b32 s15, s23, 229376
    buffer_load_dwordx4 v103, s[32:35], s15 offen lds
    s_add_u32 m0, s13, 7168
    s_xor_b32 s15, s23, 245760
    buffer_load_dwordx4 v103, s[32:35], s15 offen lds
    s_waitcnt vmcnt(0)
    s_mov_b64 exec, 1
    ds_add_u32 v112, v2 offset:80
    s_mov_b64 exec, -1
    s_mov_b64 exec, 0
    s_cmp_eq_u32 s18, 1
    s_cbranch_scc1 L_pga2
    s_cmp_eq_u32 s18, 2
    s_cbranch_scc1 L_pga3
    s_cmp_eq_u32 s18, 3
    s_cbranch_scc1 L_pgg4
    s_branch L_pga1
L_rta1:
    s_branch L_pgg1
L_rtg1:
    s_branch L_rtg4
L_rta2:
    s_branch L_pgg2
L_rtg2:
    s_branch L_rtg4
L_rta3:
    s_branch L_pgg3
L_rtg3:
    s_branch L_rtg4
L_rtg4:
    s_mov_b64 exec, -1
    s_mov_b64 s[44:45], s[52:53]
    s_mov_b32 s46, 524288
    s_mov_b32 s47, 0x00020000
    s_mov_b64 s[48:49], s[56:57]
    s_mov_b32 s50, 1409024
    s_mov_b32 s51, 0x00020000
    s_mov_b64 s[52:53], s[58:59]
    s_mov_b32 s54, 1409024
    s_mov_b32 s55, 0x00020000
    s_mov_b64 s[56:57], s[62:63]
    s_mov_b32 s58, 256
    s_mov_b32 s59, 0x00020000
    s_mov_b32 s62, 2097152
    s_mov_b32 s63, 0x00020000
    s_mul_i32 s98, s27, 196608
    s_add_u32 s98, s98, 2359296
    s_add_u32 s68, s64, s98
    s_addc_u32 s69, s65, 0
    s_mov_b32 s70, 176128
    s_mov_b32 s71, 0x00020000
    s_xor_b32 s4, s18, 2
    s_mul_i32 s4, s4, 12288
    s_add_u32 s4, s4, 107520
    v_add_u32 v11, s13, v8
    v_add_u32 v12, s4, v8
    s_mul_i32 s6, s11, 704512
    s_mul_i32 s4, s3, 384
    s_add_u32 s6, s6, s4
    s_mul_i32 s4, s12, 192
    s_add_u32 s6, s6, s4
    s_mov_b32 s4, 0x15555556
    s_cmp_eq_u32 s3, 7
    s_cselect_b32 s5, 4, 12
    v_mov_b32 v7, 2147418112
    v_add_u32 v4, 0, v0
    v_mul_hi_u32 v5, v4, s4
    v_mul_u32_u24 v6, 12, v5
    v_sub_u32 v6, v4, v6
    v_cmp_gt_u32 vcc, s5, v6
    v_bfe_u32 v4, v5, 3, 1
    v_lshlrev_b32 v4, 1, v4
    v_xor_b32 v6, v6, v4
    v_mul_u32_u24 v5, 2752, v5
    v_lshl_add_u32 v116, v6, 4, v5
    v_cndmask_b32 v116, v7, v116, vcc
    v_add_u32 v4, 64, v0
    v_mul_hi_u32 v5, v4, s4
    v_mul_u32_u24 v6, 12, v5
    v_sub_u32 v6, v4, v6
    v_cmp_gt_u32 vcc, s5, v6
    v_bfe_u32 v4, v5, 3, 1
    v_lshlrev_b32 v4, 1, v4
    v_xor_b32 v6, v6, v4
    v_mul_u32_u24 v5, 2752, v5
    v_lshl_add_u32 v117, v6, 4, v5
    v_subrev_u32 v117, 1024, v117
    v_cndmask_b32 v117, v7, v117, vcc
    v_add_u32 v4, 128, v0
    v_mul_hi_u32 v5, v4, s4
    v_mul_u32_u24 v6, 12, v5
    v_sub_u32 v6, v4, v6
    v_cmp_gt_u32 vcc, s5, v6
    v_bfe_u32 v4, v5, 3, 1
    v_lshlrev_b32 v4, 1, v4
    v_xor_b32 v6, v6, v4
    v_mul_u32_u24 v5, 2752, v5
    v_lshl_add_u32 v118, v6, 4, v5
    v_subrev_u32 v118, 2048, v118
    v_cndmask_b32 v118, v7, v118, vcc
    v_and_b32 v4, 15, v0
    v_lshrrev_b32 v5, 4, v0
    s_and_b32 s5, s96, 3
    s_lshl_b32 s5, s5, 1
    s_mul_i32 s4, s11, 49152
    v_xor_b32 v6, s5, v5
    v_xor_b32 v7, v6, v4
    v_lshlrev_b32 v7, 4, v7
    v_lshl_add_u32 v7, v6, 9, v7
    v_add_u32 v104, s4, v7
    v_xor_b32 v105, 2112, v104
    v_xor_b32 v106, 0x8000, v104
    v_xor_b32 v107, 0x8000, v105
    v_and_b32 v6, 1, v5
    v_bfe_u32 v4, v0, 2, 2
    v_lshl_add_u32 v4, v5, 3, v4
    v_mul_u32_u24 v4, 192, v4
    v_and_b32 v7, 3, v0
    v_lshl_add_u32 v4, v7, 3, v4
    v_add_u32 v4, s13, v4
    v_lshl_add_u32 v110, v6, 5, v4
    v_xor_b32 v6, 1, v6
    v_lshl_add_u32 v111, v6, 5, v4
    v_lshrrev_b32 v4, 2, v0
    v_bfe_u32 v5, v0, 3, 2
    v_lshlrev_b32 v4, 7, v4
    v_lshl_add_u32 v4, v5, 5, v4
    v_lshl_add_u32 v4, v7, 3, v4
    s_lshl_b32 s25, s18, 13
    s_add_u32 s25, s25, 65536
    v_add_u32 v124, s25, v4
    v_xor_b32 v125, 32, v124
    v_xor_b32 v126, 64, v124
    v_xor_b32 v127, 96, v124
    v_add_u32 v14, s25, v8
    v_xor_b32 v13, 0x2000, v14
    v_lshrrev_b32 v4, 3, v0
    v_and_b32 v5, 7, v0
    v_lshrrev_b32 v6, 4, v0
    v_lshlrev_b32 v6, 1, v6
    v_xor_b32 v5, v5, v6
    v_lshlrev_b32 v120, 10, v4
    v_lshl_add_u32 v120, v5, 4, v120
    v_add_u32 v121, 7168, v120
    s_lshl_b32 s4, s12, 11
    v_add_u32 v122, s4, v8
    v_xor_b32 v123, 2048, v122
    s_lshl_b32 s7, s27, 8
    s_add_u32 s7, s7, 9371648
    s_setprio 2
    v_mov_b32 v4, -1
    v_mov_b32 v5, -1
    v_mov_b32 v6, -1
    v_mov_b32 v7, -1
    s_lshl_b32 s21, s27, 16
    s_lshl_b32 s5, s3, 12
    s_add_u32 s21, s21, s5
    s_lshl_b32 s5, s18, 10
    s_add_u32 s21, s21, s5
    s_add_u32 s21, s21, 131072
    s_add_u32 s22, s21, 32768
    s_lshl_b32 s4, s24, 1
    s_add_u32 s4, s4, s3
    s_and_b32 s4, s4, 7
    s_mul_i32 s4, s4, 11
    s_lshr_b32 s4, s4, 3
    s_mul_i32 s9, s18, 11
    s_add_u32 s4, s4, s9
    s_add_u32 s9, s9, 11
    s_lshl_b32 s42, s4, 12
    s_lshl_b32 s43, s9, 12
    s_lshl_b32 s40, s4, 15
    s_lshl_b32 s41, s9, 15
    s_lshl_b32 s4, s3, 7
    s_add_u32 s40, s40, s4
    s_lshl_b32 s23, s18, 3
    s_lshl_b32 s9, s24, 1
    s_or_b32 s23, s23, s9
    s_lshl_b32 s23, s23, 14
L_pgg1:
    s_cbranch_execz L_rtg1
    s_or_b32 s23, s23, s4
    s_and_b32 s14, s3, 3
    s_lshl_b32 s14, s14, 2
    s_branch L_spf_34
L_sp_32:
    s_sleep 2
L_spf_34:
    ds_read_b32 v1, v9 offset:96
    s_sub_u32 s10, s10, 1
    s_cmp_lt_i32 s10, 0
    s_cbranch_scc1 L_spd_33
    s_waitcnt lgkmcnt(0)
    v_readfirstlane_b32 s9, v1
    s_cmp_lt_u32 s9, 4
    s_cbranch_scc1 L_sp_32
L_spd_33:
    s_lshl_b32 s4, s3, 1
    s_or_b32 s4, s4, s12
    s_cmp_lg_u32 s4, 15
    s_cbranch_scc1 L_w1_35
    buffer_store_dwordx4 v[4:7], v8, s[64:67], s21 offen sc1
    buffer_store_dwordx4 v[4:7], v8, s[64:67], s22 offen sc1
    s_mov_b64 exec, 1
    ds_add_u32 v9, v2 offset:24
    s_mov_b64 exec, -1
    s_add_u32 m0, s25, 0
    s_nop 0
    buffer_load_dwordx4 v120, s[52:55], s40 offen offset:0 lds
    buffer_load_dwordx4 v121, s[52:55], s40 offen offset:1024 lds
    s_add_u32 s40, s40, 16384
    s_add_u32 m0, s25, 2048
    s_nop 0
    buffer_load_dwordx4 v120, s[52:55], s40 offen offset:0 lds
    buffer_load_dwordx4 v121, s[52:55], s40 offen offset:1024 lds
    s_add_u32 s40, s40, 16384
    s_cmp_ge_u32 s40, s41
    s_cselect_b32 s9, 360448, 0
    s_sub_u32 s40, s40, s9
    s_waitcnt vmcnt(4)
    s_add_u32 m0, s25, 4096
    s_nop 0
    buffer_load_dwordx4 v120, s[52:55], s40 offen offset:0 lds
    buffer_load_dwordx4 v121, s[52:55], s40 offen offset:1024 lds
    s_add_u32 s40, s40, 16384
    s_waitcnt vmcnt(4)
    s_add_u32 m0, s25, 6144
    s_nop 0
    buffer_load_dwordx4 v120, s[52:55], s40 offen offset:0 lds
    buffer_load_dwordx4 v121, s[52:55], s40 offen offset:1024 lds
    s_add_u32 s40, s40, 16384
    s_cmp_ge_u32 s40, s41
    s_cselect_b32 s9, 360448, 0
    s_sub_u32 s40, s40, s9
    s_branch L_spf_38
L_sp_36:
    s_sleep 8
L_spf_38:
    ds_read_b32 v1, v9 offset:24
    s_sub_u32 s10, s10, 1
    s_cmp_lt_i32 s10, 0
    s_cbranch_scc1 L_spd_37
    s_waitcnt lgkmcnt(0)
    v_readfirstlane_b32 s9, v1
    s_cmp_lt_u32 s9, 4
    s_cbranch_scc1 L_sp_36
L_spd_37:
    s_waitcnt vmcnt(4)
    s_xor_b32 s15, s23, 0
    s_lshr_b32 s9, s15, 14
    s_xor_b32 s9, s9, s14
    s_lshl_b32 m0, s9, 11
    s_nop 0
    buffer_load_dwordx4 v120, s[44:47], s15 offen offset:0 lds
    buffer_load_dwordx4 v121, s[44:47], s15 offen offset:1024 lds
    s_waitcnt vmcnt(4)
    s_xor_b32 s15, s23, 16384
    s_lshr_b32 s9, s15, 14
    s_xor_b32 s9, s9, s14
    s_lshl_b32 m0, s9, 11
    s_nop 0
    buffer_load_dwordx4 v120, s[44:47], s15 offen offset:0 lds
    buffer_load_dwordx4 v121, s[44:47], s15 offen offset:1024 lds
    s_waitcnt vmcnt(4)
    s_xor_b32 s15, s23, 32768
    s_lshr_b32 s9, s15, 14
    s_xor_b32 s9, s9, s14
    s_lshl_b32 m0, s9, 11
    s_nop 0
    buffer_load_dwordx4 v120, s[44:47], s15 offen offset:0 lds
    buffer_load_dwordx4 v121, s[44:47], s15 offen offset:1024 lds
    s_waitcnt vmcnt(4)
    s_xor_b32 s15, s23, 49152
    s_lshr_b32 s9, s15, 14
    s_xor_b32 s9, s9, s14
    s_lshl_b32 m0, s9, 11
    s_nop 0
    buffer_load_dwordx4 v120, s[44:47], s15 offen offset:0 lds
    buffer_load_dwordx4 v121, s[44:47], s15 offen offset:1024 lds
    s_waitcnt vmcnt(4)
    s_xor_b32 s15, s23, 65536
    s_lshr_b32 s9, s15, 14
    s_xor_b32 s9, s9, s14
    s_lshl_b32 m0, s9, 11
    s_nop 0
    buffer_load_dwordx4 v120, s[44:47], s15 offen offset:0 lds
    buffer_load_dwordx4 v121, s[44:47], s15 offen offset:1024 lds
    s_waitcnt vmcnt(4)
    s_xor_b32 s15, s23, 81920
    s_lshr_b32 s9, s15, 14
    s_xor_b32 s9, s9, s14
    s_lshl_b32 m0, s9, 11
    s_nop 0
    buffer_load_dwordx4 v120, s[44:47], s15 offen offset:0 lds
    buffer_load_dwordx4 v121, s[44:47], s15 offen offset:1024 lds
    s_waitcnt vmcnt(4)
    s_xor_b32 s15, s23, 98304
    s_lshr_b32 s9, s15, 14
    s_xor_b32 s9, s9, s14
    s_lshl_b32 m0, s9, 11
    s_nop 0
    buffer_load_dwordx4 v120, s[44:47], s15 offen offset:0 lds
    buffer_load_dwordx4 v121, s[44:47], s15 offen offset:1024 lds
    s_waitcnt vmcnt(4)
    s_xor_b32 s15, s23, 114688
    s_lshr_b32 s9, s15, 14
    s_xor_b32 s9, s9, s14
    s_lshl_b32 m0, s9, 11
    s_nop 0
    buffer_load_dwordx4 v120, s[44:47], s15 offen offset:0 lds
    buffer_load_dwordx4 v121, s[44:47], s15 offen offset:1024 lds
    s_branch L_gskip_31
L_w1_35:
    s_add_u32 m0, s13, 0
    s_xor_b32 s15, s96, 0
    s_mul_i32 s15, s15, 44032
    s_add_u32 s15, s15, s6
    buffer_load_dwordx4 v116, s[48:51], s15 offen offset:0 lds
    buffer_load_dwordx4 v117, s[48:51], s15 offen offset:1024 lds
    buffer_load_dwordx4 v118, s[48:51], s15 offen offset:2048 lds
    s_add_u32 m0, s13, 3072
    s_xor_b32 s15, s96, 1
    s_mul_i32 s15, s15, 44032
    s_add_u32 s15, s15, s6
    buffer_load_dwordx4 v116, s[48:51], s15 offen offset:0 lds
    buffer_load_dwordx4 v117, s[48:51], s15 offen offset:1024 lds
    buffer_load_dwordx4 v118, s[48:51], s15 offen offset:2048 lds
    s_waitcnt vmcnt(3)
    s_add_u32 m0, s13, 6144
    s_xor_b32 s15, s96, 2
    s_mul_i32 s15, s15, 44032
    s_add_u32 s15, s15, s6
    buffer_load_dwordx4 v116, s[48:51], s15 offen offset:0 lds
    buffer_load_dwordx4 v117, s[48:51], s15 offen offset:1024 lds
    buffer_load_dwordx4 v118, s[48:51], s15 offen offset:2048 lds
    s_waitcnt vmcnt(3)
    s_add_u32 m0, s13, 9216
    s_xor_b32 s15, s96, 3
    s_mul_i32 s15, s15, 44032
    s_add_u32 s15, s15, s6
    buffer_load_dwordx4 v116, s[48:51], s15 offen offset:0 lds
    buffer_load_dwordx4 v117, s[48:51], s15 offen offset:1024 lds
    buffer_load_dwordx4 v118, s[48:51], s15 offen offset:2048 lds
    ds_read_b128 v[40:43], v104 offset:0
    ds_read_b128 v[44:47], v104 offset:256
    ds_read_b128 v[48:51], v106 offset:0
    ds_read_b128 v[52:55], v106 offset:256
    ds_read_b64_tr_b16 v[16:17], v110 offset:0
    ds_read_b64_tr_b16 v[18:19], v110 offset:768
    ds_read_b64_tr_b16 v[20:21], v111 offset:0
    ds_read_b64_tr_b16 v[22:23], v111 offset:768
    ds_read_b64_tr_b16 v[24:25], v110 offset:64
    ds_read_b64_tr_b16 v[26:27], v110 offset:832
    ds_read_b64_tr_b16 v[28:29], v111 offset:64
    ds_read_b64_tr_b16 v[30:31], v111 offset:832
    ds_read_b64_tr_b16 v[32:33], v110 offset:128
    ds_read_b64_tr_b16 v[34:35], v110 offset:896
    ds_read_b64_tr_b16 v[36:37], v111 offset:128
    ds_read_b64_tr_b16 v[38:39], v111 offset:896
    s_setprio 0
    s_waitcnt lgkmcnt(0)
    v_mfma_f32_16x16x32_bf16 v[176:179], v[16:19], v[48:51], 0
    v_mfma_f32_16x16x32_bf16 v[184:187], v[16:19], v[52:55], 0
    s_waitcnt vmcnt(3)
    s_add_u32 m0, s13, 0
    s_xor_b32 s15, s96, 4
    s_mul_i32 s15, s15, 44032
    s_add_u32 s15, s15, s6
    buffer_load_dwordx4 v116, s[48:51], s15 offen offset:0 lds
    buffer_load_dwordx4 v117, s[48:51], s15 offen offset:1024 lds
    buffer_load_dwordx4 v118, s[48:51], s15 offen offset:2048 lds
    s_waitcnt vmcnt(3)
    s_add_u32 m0, s13, 3072
    s_xor_b32 s15, s96, 5
    s_mul_i32 s15, s15, 44032
    s_add_u32 s15, s15, s6
    buffer_load_dwordx4 v116, s[48:51], s15 offen offset:0 lds
    buffer_load_dwordx4 v117, s[48:51], s15 offen offset:1024 lds
    buffer_load_dwordx4 v118, s[48:51], s15 offen offset:2048 lds
    v_mfma_f32_16x16x32_bf16 v[180:183], v[20:23], v[48:51], 0
    v_mfma_f32_16x16x32_bf16 v[188:191], v[20:23], v[52:55], 0
    ds_read_b128 v[80:83], v105 offset:0
    v_mfma_f32_16x16x32_bf16 v[192:195], v[24:27], v[48:51], 0
    v_mfma_f32_16x16x32_bf16 v[200:203], v[24:27], v[52:55], 0
    ds_read_b128 v[84:87], v105 offset:256
    v_mfma_f32_16x16x32_bf16 v[196:199], v[28:31], v[48:51], 0
    v_mfma_f32_16x16x32_bf16 v[204:207], v[28:31], v[52:55], 0
    ds_read_b128 v[88:91], v107 offset:0
    v_mfma_f32_16x16x32_bf16 v[208:211], v[32:35], v[48:51], 0
    v_mfma_f32_16x16x32_bf16 v[216:219], v[32:35], v[52:55], 0
    ds_read_b128 v[92:95], v107 offset:256
    v_mfma_f32_16x16x32_bf16 v[212:215], v[36:39], v[48:51], 0
    v_mfma_f32_16x16x32_bf16 v[220:223], v[36:39], v[52:55], 0
    ds_read_b64_tr_b16 v[56:57], v110 offset:6144
    ds_read_b64_tr_b16 v[58:59], v110 offset:6912
    v_mfma_f32_16x16x32_bf16 v[128:131], v[16:19], v[40:43], 0
    v_mfma_f32_16x16x32_bf16 v[136:139], v[16:19], v[44:47], 0
    ds_read_b64_tr_b16 v[60:61], v111 offset:6144
    ds_read_b64_tr_b16 v[62:63], v111 offset:6912
    ds_read_b64_tr_b16 v[64:65], v110 offset:6208
    ds_read_b64_tr_b16 v[66:67], v110 offset:6976
    v_mfma_f32_16x16x32_bf16 v[132:135], v[20:23], v[40:43], 0
    v_mfma_f32_16x16x32_bf16 v[140:143], v[20:23], v[44:47], 0
    ds_read_b64_tr_b16 v[68:69], v111 offset:6208
    ds_read_b64_tr_b16 v[70:71], v111 offset:6976
    v_mfma_f32_16x16x32_bf16 v[144:147], v[24:27], v[40:43], 0
    v_mfma_f32_16x16x32_bf16 v[152:155], v[24:27], v[44:47], 0
    ds_read_b64_tr_b16 v[72:73], v110 offset:6272
    ds_read_b64_tr_b16 v[74:75], v110 offset:7040
    v_mfma_f32_16x16x32_bf16 v[148:151], v[28:31], v[40:43], 0
    v_mfma_f32_16x16x32_bf16 v[156:159], v[28:31], v[44:47], 0
    ds_read_b64_tr_b16 v[76:77], v111 offset:6272
    ds_read_b64_tr_b16 v[78:79], v111 offset:7040
    v_mfma_f32_16x16x32_bf16 v[160:163], v[32:35], v[40:43], 0
    v_mfma_f32_16x16x32_bf16 v[168:171], v[32:35], v[44:47], 0
    v_mfma_f32_16x16x32_bf16 v[164:167], v[36:39], v[40:43], 0
    v_mfma_f32_16x16x32_bf16 v[172:175], v[36:39], v[44:47], 0
    s_waitcnt lgkmcnt(0)
    v_mfma_f32_16x16x32_bf16 v[176:179], v[56:59], v[88:91], v[176:179]
    v_mfma_f32_16x16x32_bf16 v[184:187], v[56:59], v[92:95], v[184:187]
    s_add_u32 m0, s13, 6144
    s_xor_b32 s15, s96, 6
    s_mul_i32 s15, s15, 44032
    s_add_u32 s15, s15, s6
    buffer_load_dwordx4 v116, s[48:51], s15 offen offset:0 lds
    buffer_load_dwordx4 v117, s[48:51], s15 offen offset:1024 lds
    buffer_load_dwordx4 v118, s[48:51], s15 offen offset:2048 lds
    s_add_u32 m0, s13, 9216
    s_xor_b32 s15, s96, 7
    s_mul_i32 s15, s15, 44032
    s_add_u32 s15, s15, s6
    buffer_load_dwordx4 v116, s[48:51], s15 offen offset:0 lds
    buffer_load_dwordx4 v117, s[48:51], s15 offen offset:1024 lds
    buffer_load_dwordx4 v118, s[48:51], s15 offen offset:2048 lds
    v_mfma_f32_16x16x32_bf16 v[180:183], v[60:63], v[88:91], v[180:183]
    v_mfma_f32_16x16x32_bf16 v[188:191], v[60:63], v[92:95], v[188:191]
    ds_read_b128 v[40:43], v104 offset:4096
    v_mfma_f32_16x16x32_bf16 v[192:195], v[64:67], v[88:91], v[192:195]
    v_mfma_f32_16x16x32_bf16 v[200:203], v[64:67], v[92:95], v[200:203]
    ds_read_b128 v[44:47], v104 offset:4352
    v_mfma_f32_16x16x32_bf16 v[196:199], v[68:71], v[88:91], v[196:199]
    v_mfma_f32_16x16x32_bf16 v[204:207], v[68:71], v[92:95], v[204:207]
    ds_read_b128 v[48:51], v106 offset:4096
    v_mfma_f32_16x16x32_bf16 v[208:211], v[72:75], v[88:91], v[208:211]
    v_mfma_f32_16x16x32_bf16 v[216:219], v[72:75], v[92:95], v[216:219]
    ds_read_b128 v[52:55], v106 offset:4352
    v_mfma_f32_16x16x32_bf16 v[212:215], v[76:79], v[88:91], v[212:215]
    v_mfma_f32_16x16x32_bf16 v[220:223], v[76:79], v[92:95], v[220:223]
    s_waitcnt vmcnt(6)
    ds_read_b64_tr_b16 v[16:17], v110 offset:0
    ds_read_b64_tr_b16 v[18:19], v110 offset:768
    v_mfma_f32_16x16x32_bf16 v[128:131], v[56:59], v[80:83], v[128:131]
    v_mfma_f32_16x16x32_bf16 v[136:139], v[56:59], v[84:87], v[136:139]
    ds_read_b64_tr_b16 v[20:21], v111 offset:0
    ds_read_b64_tr_b16 v[22:23], v111 offset:768
    ds_read_b64_tr_b16 v[24:25], v110 offset:64
    ds_read_b64_tr_b16 v[26:27], v110 offset:832
    v_mfma_f32_16x16x32_bf16 v[132:135], v[60:63], v[80:83], v[132:135]
    v_mfma_f32_16x16x32_bf16 v[140:143], v[60:63], v[84:87], v[140:143]
    ds_read_b64_tr_b16 v[28:29], v111 offset:64
    ds_read_b64_tr_b16 v[30:31], v111 offset:832
    v_mfma_f32_16x16x32_bf16 v[144:147], v[64:67], v[80:83], v[144:147]
    v_mfma_f32_16x16x32_bf16 v[152:155], v[64:67], v[84:87], v[152:155]
    ds_read_b64_tr_b16 v[32:33], v110 offset:128
    ds_read_b64_tr_b16 v[34:35], v110 offset:896
    v_mfma_f32_16x16x32_bf16 v[148:151], v[68:71], v[80:83], v[148:151]
    v_mfma_f32_16x16x32_bf16 v[156:159], v[68:71], v[84:87], v[156:159]
    ds_read_b64_tr_b16 v[36:37], v111 offset:128
    ds_read_b64_tr_b16 v[38:39], v111 offset:896
    v_mfma_f32_16x16x32_bf16 v[160:163], v[72:75], v[80:83], v[160:163]
    v_mfma_f32_16x16x32_bf16 v[168:171], v[72:75], v[84:87], v[168:171]
    v_mfma_f32_16x16x32_bf16 v[164:167], v[76:79], v[80:83], v[164:167]
    v_mfma_f32_16x16x32_bf16 v[172:175], v[76:79], v[84:87], v[172:175]
    s_waitcnt lgkmcnt(0)
    v_mfma_f32_16x16x32_bf16 v[176:179], v[16:19], v[48:51], v[176:179]
    v_mfma_f32_16x16x32_bf16 v[184:187], v[16:19], v[52:55], v[184:187]
    s_add_u32 m0, s13, 0
    s_xor_b32 s15, s96, 8
    s_mul_i32 s15, s15, 44032
    s_add_u32 s15, s15, s6
    buffer_load_dwordx4 v116, s[48:51], s15 offen offset:0 lds
    buffer_load_dwordx4 v117, s[48:51], s15 offen offset:1024 lds
    buffer_load_dwordx4 v118, s[48:51], s15 offen offset:2048 lds
    s_add_u32 m0, s13, 3072
    s_xor_b32 s15, s96, 9
    s_mul_i32 s15, s15, 44032
    s_add_u32 s15, s15, s6
    buffer_load_dwordx4 v116, s[48:51], s15 offen offset:0 lds
    buffer_load_dwordx4 v117, s[48:51], s15 offen offset:1024 lds
    buffer_load_dwordx4 v118, s[48:51], s15 offen offset:2048 lds
    v_mfma_f32_16x16x32_bf16 v[180:183], v[20:23], v[48:51], v[180:183]
    v_mfma_f32_16x16x32_bf16 v[188:191], v[20:23], v[52:55], v[188:191]
    ds_read_b128 v[80:83], v105 offset:4096
    v_mfma_f32_16x16x32_bf16 v[192:195], v[24:27], v[48:51], v[192:195]
    v_mfma_f32_16x16x32_bf16 v[200:203], v[24:27], v[52:55], v[200:203]
    ds_read_b128 v[84:87], v105 offset:4352
    v_mfma_f32_16x16x32_bf16 v[196:199], v[28:31], v[48:51], v[196:199]
    v_mfma_f32_16x16x32_bf16 v[204:207], v[28:31], v[52:55], v[204:207]
    ds_read_b128 v[88:91], v107 offset:4096
    v_mfma_f32_16x16x32_bf16 v[208:211], v[32:35], v[48:51], v[208:211]
    v_mfma_f32_16x16x32_bf16 v[216:219], v[32:35], v[52:55], v[216:219]
    ds_read_b128 v[92:95], v107 offset:4352
    v_mfma_f32_16x16x32_bf16 v[212:215], v[36:39], v[48:51], v[212:215]
    v_mfma_f32_16x16x32_bf16 v[220:223], v[36:39], v[52:55], v[220:223]
    s_waitcnt vmcnt(6)
    ds_read_b64_tr_b16 v[56:57], v110 offset:6144
    ds_read_b64_tr_b16 v[58:59], v110 offset:6912
    v_mfma_f32_16x16x32_bf16 v[128:131], v[16:19], v[40:43], v[128:131]
    v_mfma_f32_16x16x32_bf16 v[136:139], v[16:19], v[44:47], v[136:139]
    ds_read_b64_tr_b16 v[60:61], v111 offset:6144
    ds_read_b64_tr_b16 v[62:63], v111 offset:6912
    ds_read_b64_tr_b16 v[64:65], v110 offset:6208
    ds_read_b64_tr_b16 v[66:67], v110 offset:6976
    v_mfma_f32_16x16x32_bf16 v[132:135], v[20:23], v[40:43], v[132:135]
    v_mfma_f32_16x16x32_bf16 v[140:143], v[20:23], v[44:47], v[140:143]
    ds_read_b64_tr_b16 v[68:69], v111 offset:6208
    ds_read_b64_tr_b16 v[70:71], v111 offset:6976
    v_mfma_f32_16x16x32_bf16 v[144:147], v[24:27], v[40:43], v[144:147]
    v_mfma_f32_16x16x32_bf16 v[152:155], v[24:27], v[44:47], v[152:155]
    ds_read_b64_tr_b16 v[72:73], v110 offset:6272
    ds_read_b64_tr_b16 v[74:75], v110 offset:7040
    v_mfma_f32_16x16x32_bf16 v[148:151], v[28:31], v[40:43], v[148:151]
    v_mfma_f32_16x16x32_bf16 v[156:159], v[28:31], v[44:47], v[156:159]
    ds_read_b64_tr_b16 v[76:77], v111 offset:6272
    ds_read_b64_tr_b16 v[78:79], v111 offset:7040
    v_mfma_f32_16x16x32_bf16 v[160:163], v[32:35], v[40:43], v[160:163]
    v_mfma_f32_16x16x32_bf16 v[168:171], v[32:35], v[44:47], v[168:171]
    v_mfma_f32_16x16x32_bf16 v[164:167], v[36:39], v[40:43], v[164:167]
    v_mfma_f32_16x16x32_bf16 v[172:175], v[36:39], v[44:47], v[172:175]
    s_waitcnt lgkmcnt(0)
    v_mfma_f32_16x16x32_bf16 v[176:179], v[56:59], v[88:91], v[176:179]
    v_mfma_f32_16x16x32_bf16 v[184:187], v[56:59], v[92:95], v[184:187]
    s_add_u32 m0, s13, 6144
    s_xor_b32 s15, s96, 10
    s_mul_i32 s15, s15, 44032
    s_add_u32 s15, s15, s6
    buffer_load_dwordx4 v116, s[48:51], s15 offen offset:0 lds
    buffer_load_dwordx4 v117, s[48:51], s15 offen offset:1024 lds
    buffer_load_dwordx4 v118, s[48:51], s15 offen offset:2048 lds
    s_add_u32 m0, s13, 9216
    s_xor_b32 s15, s96, 11
    s_mul_i32 s15, s15, 44032
    s_add_u32 s15, s15, s6
    buffer_load_dwordx4 v116, s[48:51], s15 offen offset:0 lds
    buffer_load_dwordx4 v117, s[48:51], s15 offen offset:1024 lds
    buffer_load_dwordx4 v118, s[48:51], s15 offen offset:2048 lds
    v_mfma_f32_16x16x32_bf16 v[180:183], v[60:63], v[88:91], v[180:183]
    v_mfma_f32_16x16x32_bf16 v[188:191], v[60:63], v[92:95], v[188:191]
    s_add_u32 m0, s25, 0
    s_nop 0
    buffer_load_dwordx4 v120, s[52:55], s40 offen offset:0 lds
    buffer_load_dwordx4 v121, s[52:55], s40 offen offset:1024 lds
    s_add_u32 s40, s40, 16384
    v_mfma_f32_16x16x32_bf16 v[192:195], v[64:67], v[88:91], v[192:195]
    v_mfma_f32_16x16x32_bf16 v[200:203], v[64:67], v[92:95], v[200:203]
    ds_read_b128 v[40:43], v104 offset:8192
    v_mfma_f32_16x16x32_bf16 v[196:199], v[68:71], v[88:91], v[196:199]
    v_mfma_f32_16x16x32_bf16 v[204:207], v[68:71], v[92:95], v[204:207]
    ds_read_b128 v[44:47], v104 offset:8448
    v_mfma_f32_16x16x32_bf16 v[208:211], v[72:75], v[88:91], v[208:211]
    v_mfma_f32_16x16x32_bf16 v[216:219], v[72:75], v[92:95], v[216:219]
    ds_read_b128 v[48:51], v106 offset:8192
    ds_read_b128 v[52:55], v106 offset:8448
    v_mfma_f32_16x16x32_bf16 v[212:215], v[76:79], v[88:91], v[212:215]
    v_mfma_f32_16x16x32_bf16 v[220:223], v[76:79], v[92:95], v[220:223]
    s_waitcnt vmcnt(8)
    ds_read_b64_tr_b16 v[16:17], v110 offset:0
    ds_read_b64_tr_b16 v[18:19], v110 offset:768
    v_mfma_f32_16x16x32_bf16 v[128:131], v[56:59], v[80:83], v[128:131]
    v_mfma_f32_16x16x32_bf16 v[136:139], v[56:59], v[84:87], v[136:139]
    ds_read_b64_tr_b16 v[20:21], v111 offset:0
    ds_read_b64_tr_b16 v[22:23], v111 offset:768
    v_mfma_f32_16x16x32_bf16 v[132:135], v[60:63], v[80:83], v[132:135]
    v_mfma_f32_16x16x32_bf16 v[140:143], v[60:63], v[84:87], v[140:143]
    ds_read_b64_tr_b16 v[24:25], v110 offset:64
    ds_read_b64_tr_b16 v[26:27], v110 offset:832
    v_mfma_f32_16x16x32_bf16 v[144:147], v[64:67], v[80:83], v[144:147]
    v_mfma_f32_16x16x32_bf16 v[152:155], v[64:67], v[84:87], v[152:155]
    ds_read_b64_tr_b16 v[28:29], v111 offset:64
    ds_read_b64_tr_b16 v[30:31], v111 offset:832
    ds_read_b64_tr_b16 v[32:33], v110 offset:128
    ds_read_b64_tr_b16 v[34:35], v110 offset:896
    v_mfma_f32_16x16x32_bf16 v[148:151], v[68:71], v[80:83], v[148:151]
    v_mfma_f32_16x16x32_bf16 v[156:159], v[68:71], v[84:87], v[156:159]
    ds_read_b64_tr_b16 v[36:37], v111 offset:128
    ds_read_b64_tr_b16 v[38:39], v111 offset:896
    v_mfma_f32_16x16x32_bf16 v[160:163], v[72:75], v[80:83], v[160:163]
    v_mfma_f32_16x16x32_bf16 v[168:171], v[72:75], v[84:87], v[168:171]
    v_mfma_f32_16x16x32_bf16 v[164:167], v[76:79], v[80:83], v[164:167]
    v_mfma_f32_16x16x32_bf16 v[172:175], v[76:79], v[84:87], v[172:175]
    s_waitcnt lgkmcnt(0)
    v_mfma_f32_16x16x32_bf16 v[176:179], v[16:19], v[48:51], v[176:179]
    v_mfma_f32_16x16x32_bf16 v[184:187], v[16:19], v[52:55], v[184:187]
    s_add_u32 m0, s13, 0
    s_xor_b32 s15, s96, 12
    s_mul_i32 s15, s15, 44032
    s_add_u32 s15, s15, s6
    buffer_load_dwordx4 v116, s[48:51], s15 offen offset:0 lds
    buffer_load_dwordx4 v117, s[48:51], s15 offen offset:1024 lds
    buffer_load_dwordx4 v118, s[48:51], s15 offen offset:2048 lds
    s_add_u32 m0, s13, 3072
    s_xor_b32 s15, s96, 13
    s_mul_i32 s15, s15, 44032
    s_add_u32 s15, s15, s6
    buffer_load_dwordx4 v116, s[48:51], s15 offen offset:0 lds
    buffer_load_dwordx4 v117, s[48:51], s15 offen offset:1024 lds
    buffer_load_dwordx4 v118, s[48:51], s15 offen offset:2048 lds
    v_mfma_f32_16x16x32_bf16 v[180:183], v[20:23], v[48:51], v[180:183]
    v_mfma_f32_16x16x32_bf16 v[188:191], v[20:23], v[52:55], v[188:191]
    s_add_u32 m0, s25, 2048
    s_nop 0
    buffer_load_dwordx4 v120, s[52:55], s40 offen offset:0 lds
    buffer_load_dwordx4 v121, s[52:55], s40 offen offset:1024 lds
    s_add_u32 s40, s40, 16384
    s_cmp_ge_u32 s40, s41
    s_cselect_b32 s9, 360448, 0
    s_sub_u32 s40, s40, s9
    v_mfma_f32_16x16x32_bf16 v[192:195], v[24:27], v[48:51], v[192:195]
    v_mfma_f32_16x16x32_bf16 v[200:203], v[24:27], v[52:55], v[200:203]
    ds_read_b128 v[80:83], v105 offset:8192
    v_mfma_f32_16x16x32_bf16 v[196:199], v[28:31], v[48:51], v[196:199]
    v_mfma_f32_16x16x32_bf16 v[204:207], v[28:31], v[52:55], v[204:207]
    ds_read_b128 v[84:87], v105 offset:8448
    v_mfma_f32_16x16x32_bf16 v[208:211], v[32:35], v[48:51], v[208:211]
    v_mfma_f32_16x16x32_bf16 v[216:219], v[32:35], v[52:55], v[216:219]
    ds_read_b128 v[88:91], v107 offset:8192
    ds_read_b128 v[92:95], v107 offset:8448
    v_mfma_f32_16x16x32_bf16 v[212:215], v[36:39], v[48:51], v[212:215]
    v_mfma_f32_16x16x32_bf16 v[220:223], v[36:39], v[52:55], v[220:223]
    s_waitcnt vmcnt(10)
    ds_read_b64_tr_b16 v[56:57], v110 offset:6144
    ds_read_b64_tr_b16 v[58:59], v110 offset:6912
    v_mfma_f32_16x16x32_bf16 v[128:131], v[16:19], v[40:43], v[128:131]
    v_mfma_f32_16x16x32_bf16 v[136:139], v[16:19], v[44:47], v[136:139]
    ds_read_b64_tr_b16 v[60:61], v111 offset:6144
    ds_read_b64_tr_b16 v[62:63], v111 offset:6912
    v_mfma_f32_16x16x32_bf16 v[132:135], v[20:23], v[40:43], v[132:135]
    v_mfma_f32_16x16x32_bf16 v[140:143], v[20:23], v[44:47], v[140:143]
    ds_read_b64_tr_b16 v[64:65], v110 offset:6208
    ds_read_b64_tr_b16 v[66:67], v110 offset:6976
    v_mfma_f32_16x16x32_bf16 v[144:147], v[24:27], v[40:43], v[144:147]
    v_mfma_f32_16x16x32_bf16 v[152:155], v[24:27], v[44:47], v[152:155]
    ds_read_b64_tr_b16 v[68:69], v111 offset:6208
    ds_read_b64_tr_b16 v[70:71], v111 offset:6976
    ds_read_b64_tr_b16 v[72:73], v110 offset:6272
    ds_read_b64_tr_b16 v[74:75], v110 offset:7040
    v_mfma_f32_16x16x32_bf16 v[148:151], v[28:31], v[40:43], v[148:151]
    v_mfma_f32_16x16x32_bf16 v[156:159], v[28:31], v[44:47], v[156:159]
    ds_read_b64_tr_b16 v[76:77], v111 offset:6272
    ds_read_b64_tr_b16 v[78:79], v111 offset:7040
    v_mfma_f32_16x16x32_bf16 v[160:163], v[32:35], v[40:43], v[160:163]
    v_mfma_f32_16x16x32_bf16 v[168:171], v[32:35], v[44:47], v[168:171]
    v_mfma_f32_16x16x32_bf16 v[164:167], v[36:39], v[40:43], v[164:167]
    v_mfma_f32_16x16x32_bf16 v[172:175], v[36:39], v[44:47], v[172:175]
    s_waitcnt lgkmcnt(0)
    v_mfma_f32_16x16x32_bf16 v[176:179], v[56:59], v[88:91], v[176:179]
    v_mfma_f32_16x16x32_bf16 v[184:187], v[56:59], v[92:95], v[184:187]
    s_add_u32 m0, s13, 6144
    s_xor_b32 s15, s96, 14
    s_mul_i32 s15, s15, 44032
    s_add_u32 s15, s15, s6
    buffer_load_dwordx4 v116, s[48:51], s15 offen offset:0 lds
    buffer_load_dwordx4 v117, s[48:51], s15 offen offset:1024 lds
    buffer_load_dwordx4 v118, s[48:51], s15 offen offset:2048 lds
    s_add_u32 m0, s13, 9216
    s_xor_b32 s15, s96, 15
    s_mul_i32 s15, s15, 44032
    s_add_u32 s15, s15, s6
    buffer_load_dwordx4 v116, s[48:51], s15 offen offset:0 lds
    buffer_load_dwordx4 v117, s[48:51], s15 offen offset:1024 lds
    buffer_load_dwordx4 v118, s[48:51], s15 offen offset:2048 lds
    v_mfma_f32_16x16x32_bf16 v[180:183], v[60:63], v[88:91], v[180:183]
    v_mfma_f32_16x16x32_bf16 v[188:191], v[60:63], v[92:95], v[188:191]
    s_add_u32 m0, s25, 4096
    s_nop 0
    buffer_load_dwordx4 v120, s[52:55], s40 offen offset:0 lds
    buffer_load_dwordx4 v121, s[52:55], s40 offen offset:1024 lds
    s_add_u32 s40, s40, 16384
    v_mfma_f32_16x16x32_bf16 v[192:195], v[64:67], v[88:91], v[192:195]
    v_mfma_f32_16x16x32_bf16 v[200:203], v[64:67], v[92:95], v[200:203]
    ds_read_b128 v[40:43], v104 offset:12288
    v_mfma_f32_16x16x32_bf16 v[196:199], v[68:71], v[88:91], v[196:199]
    v_mfma_f32_16x16x32_bf16 v[204:207], v[68:71], v[92:95], v[204:207]
    ds_read_b128 v[44:47], v104 offset:12544
    v_mfma_f32_16x16x32_bf16 v[208:211], v[72:75], v[88:91], v[208:211]
    v_mfma_f32_16x16x32_bf16 v[216:219], v[72:75], v[92:95], v[216:219]
    ds_read_b128 v[48:51], v106 offset:12288
    ds_read_b128 v[52:55], v106 offset:12544
    v_mfma_f32_16x16x32_bf16 v[212:215], v[76:79], v[88:91], v[212:215]
    v_mfma_f32_16x16x32_bf16 v[220:223], v[76:79], v[92:95], v[220:223]
    s_waitcnt vmcnt(10)
    ds_read_b64_tr_b16 v[16:17], v110 offset:0
    ds_read_b64_tr_b16 v[18:19], v110 offset:768
    v_mfma_f32_16x16x32_bf16 v[128:131], v[56:59], v[80:83], v[128:131]
    v_mfma_f32_16x16x32_bf16 v[136:139], v[56:59], v[84:87], v[136:139]
    ds_read_b64_tr_b16 v[20:21], v111 offset:0
    ds_read_b64_tr_b16 v[22:23], v111 offset:768
    v_mfma_f32_16x16x32_bf16 v[132:135], v[60:63], v[80:83], v[132:135]
    v_mfma_f32_16x16x32_bf16 v[140:143], v[60:63], v[84:87], v[140:143]
    ds_read_b64_tr_b16 v[24:25], v110 offset:64
    ds_read_b64_tr_b16 v[26:27], v110 offset:832
    v_mfma_f32_16x16x32_bf16 v[144:147], v[64:67], v[80:83], v[144:147]
    v_mfma_f32_16x16x32_bf16 v[152:155], v[64:67], v[84:87], v[152:155]
    ds_read_b64_tr_b16 v[28:29], v111 offset:64
    ds_read_b64_tr_b16 v[30:31], v111 offset:832
    ds_read_b64_tr_b16 v[32:33], v110 offset:128
    ds_read_b64_tr_b16 v[34:35], v110 offset:896
    v_mfma_f32_16x16x32_bf16 v[148:151], v[68:71], v[80:83], v[148:151]
    v_mfma_f32_16x16x32_bf16 v[156:159], v[68:71], v[84:87], v[156:159]
    ds_read_b64_tr_b16 v[36:37], v111 offset:128
    ds_read_b64_tr_b16 v[38:39], v111 offset:896
    v_mfma_f32_16x16x32_bf16 v[160:163], v[72:75], v[80:83], v[160:163]
    v_mfma_f32_16x16x32_bf16 v[168:171], v[72:75], v[84:87], v[168:171]
    v_mfma_f32_16x16x32_bf16 v[164:167], v[76:79], v[80:83], v[164:167]
    v_mfma_f32_16x16x32_bf16 v[172:175], v[76:79], v[84:87], v[172:175]
    s_waitcnt lgkmcnt(0)
    v_mfma_f32_16x16x32_bf16 v[176:179], v[16:19], v[48:51], v[176:179]
    v_mfma_f32_16x16x32_bf16 v[184:187], v[16:19], v[52:55], v[184:187]
    buffer_store_dwordx4 v[4:7], v8, s[64:67], s21 offen sc1
    buffer_store_dwordx4 v[4:7], v8, s[64:67], s22 offen sc1
    s_add_u32 m0, s25, 6144
    s_nop 0
    buffer_load_dwordx4 v120, s[52:55], s40 offen offset:0 lds
    buffer_load_dwordx4 v121, s[52:55], s40 offen offset:1024 lds
    s_add_u32 s40, s40, 16384
    s_cmp_ge_u32 s40, s41
    s_cselect_b32 s9, 360448, 0
    s_sub_u32 s40, s40, s9
    v_mfma_f32_16x16x32_bf16 v[180:183], v[20:23], v[48:51], v[180:183]
    v_mfma_f32_16x16x32_bf16 v[188:191], v[20:23], v[52:55], v[188:191]
    ds_read_b128 v[80:83], v105 offset:12288
    v_mfma_f32_16x16x32_bf16 v[192:195], v[24:27], v[48:51], v[192:195]
    v_mfma_f32_16x16x32_bf16 v[200:203], v[24:27], v[52:55], v[200:203]
    ds_read_b128 v[84:87], v105 offset:12544
    v_mfma_f32_16x16x32_bf16 v[196:199], v[28:31], v[48:51], v[196:199]
    v_mfma_f32_16x16x32_bf16 v[204:207], v[28:31], v[52:55], v[204:207]
    ds_read_b128 v[88:91], v107 offset:12288
    v_mfma_f32_16x16x32_bf16 v[208:211], v[32:35], v[48:51], v[208:211]
    v_mfma_f32_16x16x32_bf16 v[216:219], v[32:35], v[52:55], v[216:219]
    ds_read_b128 v[92:95], v107 offset:12544
    v_mfma_f32_16x16x32_bf16 v[212:215], v[36:39], v[48:51], v[212:215]
    v_mfma_f32_16x16x32_bf16 v[220:223], v[36:39], v[52:55], v[220:223]
    s_waitcnt vmcnt(6)
    ds_read_b64_tr_b16 v[56:57], v110 offset:6144
    ds_read_b64_tr_b16 v[58:59], v110 offset:6912
    v_mfma_f32_16x16x32_bf16 v[128:131], v[16:19], v[40:43], v[128:131]
    v_mfma_f32_16x16x32_bf16 v[136:139], v[16:19], v[44:47], v[136:139]
    ds_read_b64_tr_b16 v[60:61], v111 offset:6144
    ds_read_b64_tr_b16 v[62:63], v111 offset:6912
    ds_read_b64_tr_b16 v[64:65], v110 offset:6208
    ds_read_b64_tr_b16 v[66:67], v110 offset:6976
    v_mfma_f32_16x16x32_bf16 v[132:135], v[20:23], v[40:43], v[132:135]
    v_mfma_f32_16x16x32_bf16 v[140:143], v[20:23], v[44:47], v[140:143]
    ds_read_b64_tr_b16 v[68:69], v111 offset:6208
    ds_read_b64_tr_b16 v[70:71], v111 offset:6976
    v_mfma_f32_16x16x32_bf16 v[144:147], v[24:27], v[40:43], v[144:147]
    v_mfma_f32_16x16x32_bf16 v[152:155], v[24:27], v[44:47], v[152:155]
    ds_read_b64_tr_b16 v[72:73], v110 offset:6272
    ds_read_b64_tr_b16 v[74:75], v110 offset:7040
    v_mfma_f32_16x16x32_bf16 v[148:151], v[28:31], v[40:43], v[148:151]
    v_mfma_f32_16x16x32_bf16 v[156:159], v[28:31], v[44:47], v[156:159]
    ds_read_b64_tr_b16 v[76:77], v111 offset:6272
    ds_read_b64_tr_b16 v[78:79], v111 offset:7040
    v_mfma_f32_16x16x32_bf16 v[160:163], v[32:35], v[40:43], v[160:163]
    v_mfma_f32_16x16x32_bf16 v[168:171], v[32:35], v[44:47], v[168:171]
    v_mfma_f32_16x16x32_bf16 v[164:167], v[36:39], v[40:43], v[164:167]
    v_mfma_f32_16x16x32_bf16 v[172:175], v[36:39], v[44:47], v[172:175]
    s_waitcnt lgkmcnt(0)
    v_mfma_f32_16x16x32_bf16 v[176:179], v[56:59], v[88:91], v[176:179]
    v_mfma_f32_16x16x32_bf16 v[184:187], v[56:59], v[92:95], v[184:187]
    s_mov_b64 exec, 1
    ds_add_u32 v9, v2 offset:24
L_pgg2:
    s_cbranch_execz L_rtg2
    s_mov_b64 exec, -1
    v_mfma_f32_16x16x32_bf16 v[180:183], v[60:63], v[88:91], v[180:183]
    v_mfma_f32_16x16x32_bf16 v[188:191], v[60:63], v[92:95], v[188:191]
    v_mfma_f32_16x16x32_bf16 v[192:195], v[64:67], v[88:91], v[192:195]
    v_mfma_f32_16x16x32_bf16 v[200:203], v[64:67], v[92:95], v[200:203]
    v_mfma_f32_16x16x32_bf16 v[196:199], v[68:71], v[88:91], v[196:199]
    v_mfma_f32_16x16x32_bf16 v[204:207], v[68:71], v[92:95], v[204:207]
    v_mfma_f32_16x16x32_bf16 v[208:211], v[72:75], v[88:91], v[208:211]
    v_mfma_f32_16x16x32_bf16 v[216:219], v[72:75], v[92:95], v[216:219]
    v_mfma_f32_16x16x32_bf16 v[212:215], v[76:79], v[88:91], v[212:215]
    v_mfma_f32_16x16x32_bf16 v[220:223], v[76:79], v[92:95], v[220:223]
    s_mul_i32 s4, s3, 24576
    s_mul_i32 s9, s12, 12288
    s_add_u32 s4, s4, s9
    s_lshl_b32 s9, s11, 11
    s_add_u32 s4, s4, s9
    s_mov_b32 s98, 0xbfb8aa3b
    s_nop 3
    v_mfma_f32_16x16x32_bf16 v[128:131], v[56:59], v[80:83], v[128:131]
    ds_write_b128 v11, v[176:179] offset:0
    ds_write_b128 v11, v[180:183] offset:1024
    v_mfma_f32_16x16x32_bf16 v[136:139], v[56:59], v[84:87], v[136:139]
    ds_write_b128 v11, v[184:187] offset:2048
    v_mfma_f32_16x16x32_bf16 v[132:135], v[60:63], v[80:83], v[132:135]
    ds_write_b128 v11, v[188:191] offset:3072
    v_mfma_f32_16x16x32_bf16 v[140:143], v[60:63], v[84:87], v[140:143]
    ds_write_b128 v11, v[192:195] offset:4096
    v_mfma_f32_16x16x32_bf16 v[144:147], v[64:67], v[80:83], v[144:147]
    ds_write_b128 v11, v[196:199] offset:5120
    v_mfma_f32_16x16x32_bf16 v[152:155], v[64:67], v[84:87], v[152:155]
    ds_write_b128 v11, v[200:203] offset:6144
    ds_write_b128 v11, v[204:207] offset:7168
    v_mfma_f32_16x16x32_bf16 v[148:151], v[68:71], v[80:83], v[148:151]
    ds_write_b128 v11, v[208:211] offset:8192
    v_mfma_f32_16x16x32_bf16 v[156:159], v[68:71], v[84:87], v[156:159]
    ds_write_b128 v11, v[212:215] offset:9216
    v_mfma_f32_16x16x32_bf16 v[160:163], v[72:75], v[80:83], v[160:163]
    ds_write_b128 v11, v[216:219] offset:10240
    v_mfma_f32_16x16x32_bf16 v[168:171], v[72:75], v[84:87], v[168:171]
    ds_write_b128 v11, v[220:223] offset:11264
    v_mfma_f32_16x16x32_bf16 v[164:167], v[76:79], v[80:83], v[164:167]
    s_mov_b64 exec, 1
    ds_add_u32 v10, v2 offset:16
    s_mov_b64 exec, -1
    v_mfma_f32_16x16x32_bf16 v[172:175], v[76:79], v[84:87], v[172:175]
    s_setprio 2
    s_branch L_spf_41
L_sp_39:
    s_sleep 2
L_spf_41:
    ds_read_b32 v1, v10 offset:16
    s_sub_u32 s10, s10, 1
    s_cmp_lt_i32 s10, 0
    s_cbranch_scc1 L_spd_40
    s_waitcnt lgkmcnt(0)
    v_readfirstlane_b32 s9, v1
    s_cmp_lt_u32 s9, 2
    s_cbranch_scc1 L_sp_39
L_spd_40:
    ds_read_b128 v[176:179], v12 offset:0
    ds_read_b128 v[180:183], v12 offset:1024
    ds_read_b128 v[184:187], v12 offset:2048
    ds_read_b128 v[188:191], v12 offset:3072
    ds_read_b128 v[192:195], v12 offset:4096
    ds_read_b128 v[196:199], v12 offset:5120
    ds_read_b128 v[200:203], v12 offset:6144
    ds_read_b128 v[204:207], v12 offset:7168
    ds_read_b128 v[208:211], v12 offset:8192
    ds_read_b128 v[212:215], v12 offset:9216
    ds_read_b128 v[216:219], v12 offset:10240
    ds_read_b128 v[220:223], v12 offset:11264
    s_branch L_spf_44
L_sp_42:
    s_sleep 2
L_spf_44:
    ds_read_b32 v1, v9 offset:24
    s_sub_u32 s10, s10, 1
    s_cmp_lt_i32 s10, 0
    s_cbranch_scc1 L_spd_43
    s_waitcnt lgkmcnt(0)
    v_readfirstlane_b32 s9, v1
    s_cmp_lt_u32 s9, 4
    s_cbranch_scc1 L_sp_42
L_spd_43:
    s_waitcnt vmcnt(4)
    s_xor_b32 s15, s23, 0
    s_lshr_b32 s9, s15, 14
    s_xor_b32 s9, s9, s14
    s_lshl_b32 m0, s9, 11
    s_nop 0
    buffer_load_dwordx4 v120, s[44:47], s15 offen offset:0 lds
    buffer_load_dwordx4 v121, s[44:47], s15 offen offset:1024 lds
    s_waitcnt vmcnt(4)
    s_xor_b32 s15, s23, 16384
    s_lshr_b32 s9, s15, 14
    s_xor_b32 s9, s9, s14
    s_lshl_b32 m0, s9, 11
    s_nop 0
    buffer_load_dwordx4 v120, s[44:47], s15 offen offset:0 lds
    buffer_load_dwordx4 v121, s[44:47], s15 offen offset:1024 lds
    v_pk_add_f32 v[128:129], v[128:129], v[176:177]
    v_pk_add_f32 v[130:131], v[130:131], v[178:179]
    v_pk_add_f32 v[132:133], v[132:133], v[180:181]
    v_pk_add_f32 v[134:135], v[134:135], v[182:183]
    v_exp_f32 v176, v128
    v_exp_f32 v177, v129
    v_exp_f32 v178, v130
    v_exp_f32 v179, v131
    v_exp_f32 v180, v132
    v_exp_f32 v181, v133
    v_exp_f32 v182, v134
    v_exp_f32 v183, v135
    v_pk_fma_f32 v[176:177], v[176:177], s[98:99], s[98:99] op_sel_hi:[1,0,0]
    v_pk_fma_f32 v[178:179], v[178:179], s[98:99], s[98:99] op_sel_hi:[1,0,0]
    v_pk_fma_f32 v[180:181], v[180:181], s[98:99], s[98:99] op_sel_hi:[1,0,0]
    v_pk_fma_f32 v[182:183], v[182:183], s[98:99], s[98:99] op_sel_hi:[1,0,0]
    v_rcp_f32 v176, v176
    v_rcp_f32 v177, v177
    v_rcp_f32 v178, v178
    v_rcp_f32 v179, v179
    v_rcp_f32 v180, v180
    v_rcp_f32 v181, v181
    v_rcp_f32 v182, v182
    v_rcp_f32 v183, v183
    v_pk_mul_f32 v[128:129], v[128:129], v[176:177]
    v_pk_mul_f32 v[130:131], v[130:131], v[178:179]
    v_pk_mul_f32 v[132:133], v[132:133], v[180:181]
    v_pk_mul_f32 v[134:135], v[134:135], v[182:183]
    v_cvt_pk_bf16_f32 v16, v128, v129
    v_cvt_pk_bf16_f32 v17, v130, v131
    v_cvt_pk_bf16_f32 v18, v132, v133
    v_cvt_pk_bf16_f32 v19, v134, v135
    s_waitcnt vmcnt(4)
    s_xor_b32 s15, s23, 32768
    s_lshr_b32 s9, s15, 14
    s_xor_b32 s9, s9, s14
    s_lshl_b32 m0, s9, 11
    s_nop 0
    buffer_load_dwordx4 v120, s[44:47], s15 offen offset:0 lds
    buffer_load_dwordx4 v121, s[44:47], s15 offen offset:1024 lds
    s_waitcnt vmcnt(4)
    s_xor_b32 s15, s23, 49152
    s_lshr_b32 s9, s15, 14
    s_xor_b32 s9, s9, s14
    s_lshl_b32 m0, s9, 11
    s_nop 0
    buffer_load_dwordx4 v120, s[44:47], s15 offen offset:0 lds
    buffer_load_dwordx4 v121, s[44:47], s15 offen offset:1024 lds
    v_pk_add_f32 v[136:137], v[136:137], v[184:185]
    v_pk_add_f32 v[138:139], v[138:139], v[186:187]
    v_pk_add_f32 v[140:141], v[140:141], v[188:189]
    v_pk_add_f32 v[142:143], v[142:143], v[190:191]
    v_exp_f32 v184, v136
    v_exp_f32 v185, v137
    v_exp_f32 v186, v138
    v_exp_f32 v187, v139
    v_exp_f32 v188, v140
    v_exp_f32 v189, v141
    v_exp_f32 v190, v142
    v_exp_f32 v191, v143
    v_pk_fma_f32 v[184:185], v[184:185], s[98:99], s[98:99] op_sel_hi:[1,0,0]
    v_pk_fma_f32 v[186:187], v[186:187], s[98:99], s[98:99] op_sel_hi:[1,0,0]
    v_pk_fma_f32 v[188:189], v[188:189], s[98:99], s[98:99] op_sel_hi:[1,0,0]
    v_pk_fma_f32 v[190:191], v[190:191], s[98:99], s[98:99] op_sel_hi:[1,0,0]
    v_rcp_f32 v184, v184
    v_rcp_f32 v185, v185
    v_rcp_f32 v186, v186
    v_rcp_f32 v187, v187
    v_rcp_f32 v188, v188
    v_rcp_f32 v189, v189
    v_rcp_f32 v190, v190
    v_rcp_f32 v191, v191
    v_pk_mul_f32 v[136:137], v[136:137], v[184:185]
    v_pk_mul_f32 v[138:139], v[138:139], v[186:187]
    v_pk_mul_f32 v[140:141], v[140:141], v[188:189]
    v_pk_mul_f32 v[142:143], v[142:143], v[190:191]
    v_cvt_pk_bf16_f32 v20, v136, v137
    v_cvt_pk_bf16_f32 v21, v138, v139
    v_cvt_pk_bf16_f32 v22, v140, v141
    v_cvt_pk_bf16_f32 v23, v142, v143
    s_waitcnt vmcnt(4)
    s_xor_b32 s15, s23, 65536
    s_lshr_b32 s9, s15, 14
    s_xor_b32 s9, s9, s14
    s_lshl_b32 m0, s9, 11
    s_nop 0
    buffer_load_dwordx4 v120, s[44:47], s15 offen offset:0 lds
    buffer_load_dwordx4 v121, s[44:47], s15 offen offset:1024 lds
    s_waitcnt vmcnt(4)
    s_xor_b32 s15, s23, 81920
    s_lshr_b32 s9, s15, 14
    s_xor_b32 s9, s9, s14
    s_lshl_b32 m0, s9, 11
    s_nop 0
    buffer_load_dwordx4 v120, s[44:47], s15 offen offset:0 lds
    buffer_load_dwordx4 v121, s[44:47], s15 offen offset:1024 lds
    v_pk_add_f32 v[144:145], v[144:145], v[192:193]
    v_pk_add_f32 v[146:147], v[146:147], v[194:195]
    v_pk_add_f32 v[148:149], v[148:149], v[196:197]
    v_pk_add_f32 v[150:151], v[150:151], v[198:199]
    v_exp_f32 v192, v144
    v_exp_f32 v193, v145
    v_exp_f32 v194, v146
    v_exp_f32 v195, v147
    v_exp_f32 v196, v148
    v_exp_f32 v197, v149
    v_exp_f32 v198, v150
    v_exp_f32 v199, v151
    v_pk_fma_f32 v[192:193], v[192:193], s[98:99], s[98:99] op_sel_hi:[1,0,0]
    v_pk_fma_f32 v[194:195], v[194:195], s[98:99], s[98:99] op_sel_hi:[1,0,0]
    v_pk_fma_f32 v[196:197], v[196:197], s[98:99], s[98:99] op_sel_hi:[1,0,0]
    v_pk_fma_f32 v[198:199], v[198:199], s[98:99], s[98:99] op_sel_hi:[1,0,0]
    v_rcp_f32 v192, v192
    v_rcp_f32 v193, v193
    v_rcp_f32 v194, v194
    v_rcp_f32 v195, v195
    v_rcp_f32 v196, v196
    v_rcp_f32 v197, v197
    v_rcp_f32 v198, v198
    v_rcp_f32 v199, v199
    v_pk_mul_f32 v[144:145], v[144:145], v[192:193]
    v_pk_mul_f32 v[146:147], v[146:147], v[194:195]
    v_pk_mul_f32 v[148:149], v[148:149], v[196:197]
    v_pk_mul_f32 v[150:151], v[150:151], v[198:199]
    v_cvt_pk_bf16_f32 v24, v144, v145
    v_cvt_pk_bf16_f32 v25, v146, v147
    v_cvt_pk_bf16_f32 v26, v148, v149
    v_cvt_pk_bf16_f32 v27, v150, v151
    s_waitcnt vmcnt(4)
    s_xor_b32 s15, s23, 98304
    s_lshr_b32 s9, s15, 14
    s_xor_b32 s9, s9, s14
    s_lshl_b32 m0, s9, 11
    s_nop 0
    buffer_load_dwordx4 v120, s[44:47], s15 offen offset:0 lds
    buffer_load_dwordx4 v121, s[44:47], s15 offen offset:1024 lds
    s_waitcnt vmcnt(4)
    s_xor_b32 s15, s23, 114688
    s_lshr_b32 s9, s15, 14
    s_xor_b32 s9, s9, s14
    s_lshl_b32 m0, s9, 11
    s_nop 0
    buffer_load_dwordx4 v120, s[44:47], s15 offen offset:0 lds
    buffer_load_dwordx4 v121, s[44:47], s15 offen offset:1024 lds
    v_pk_add_f32 v[152:153], v[152:153], v[200:201]
    v_pk_add_f32 v[154:155], v[154:155], v[202:203]
    v_pk_add_f32 v[156:157], v[156:157], v[204:205]
    v_pk_add_f32 v[158:159], v[158:159], v[206:207]
    v_exp_f32 v200, v152
    v_exp_f32 v201, v153
    v_exp_f32 v202, v154
    v_exp_f32 v203, v155
    v_exp_f32 v204, v156
    v_exp_f32 v205, v157
    v_exp_f32 v206, v158
    v_exp_f32 v207, v159
    v_pk_fma_f32 v[200:201], v[200:201], s[98:99], s[98:99] op_sel_hi:[1,0,0]
    v_pk_fma_f32 v[202:203], v[202:203], s[98:99], s[98:99] op_sel_hi:[1,0,0]
    v_pk_fma_f32 v[204:205], v[204:205], s[98:99], s[98:99] op_sel_hi:[1,0,0]
    v_pk_fma_f32 v[206:207], v[206:207], s[98:99], s[98:99] op_sel_hi:[1,0,0]
    v_rcp_f32 v200, v200
    v_rcp_f32 v201, v201
    v_rcp_f32 v202, v202
    v_rcp_f32 v203, v203
    v_rcp_f32 v204, v204
    v_rcp_f32 v205, v205
    v_rcp_f32 v206, v206
    v_rcp_f32 v207, v207
    v_pk_mul_f32 v[152:153], v[152:153], v[200:201]
    v_pk_mul_f32 v[154:155], v[154:155], v[202:203]
    v_pk_mul_f32 v[156:157], v[156:157], v[204:205]
    v_pk_mul_f32 v[158:159], v[158:159], v[206:207]
    v_cvt_pk_bf16_f32 v28, v152, v153
    v_cvt_pk_bf16_f32 v29, v154, v155
    v_cvt_pk_bf16_f32 v30, v156, v157
    v_cvt_pk_bf16_f32 v31, v158, v159
    buffer_store_dwordx4 v[16:19], v8, s[68:71], s4 offen offset:0 sc1
    buffer_store_dwordx4 v[20:23], v8, s[68:71], s4 offen offset:1024 sc1
    s_add_u32 s4, s4, 4096
    buffer_store_dwordx4 v[24:27], v8, s[68:71], s4 offen offset:0 sc1
    buffer_store_dwordx4 v[28:31], v8, s[68:71], s4 offen offset:1024 sc1
    s_add_u32 s4, s4, 4096
    v_pk_add_f32 v[160:161], v[160:161], v[208:209]
    v_pk_add_f32 v[162:163], v[162:163], v[210:211]
    v_pk_add_f32 v[164:165], v[164:165], v[212:213]
    v_pk_add_f32 v[166:167], v[166:167], v[214:215]
    v_exp_f32 v208, v160
    v_exp_f32 v209, v161
    v_exp_f32 v210, v162
    v_exp_f32 v211, v163
    v_exp_f32 v212, v164
    v_exp_f32 v213, v165
    v_exp_f32 v214, v166
    v_exp_f32 v215, v167
    v_pk_fma_f32 v[208:209], v[208:209], s[98:99], s[98:99] op_sel_hi:[1,0,0]
    v_pk_fma_f32 v[210:211], v[210:211], s[98:99], s[98:99] op_sel_hi:[1,0,0]
    v_pk_fma_f32 v[212:213], v[212:213], s[98:99], s[98:99] op_sel_hi:[1,0,0]
    v_pk_fma_f32 v[214:215], v[214:215], s[98:99], s[98:99] op_sel_hi:[1,0,0]
    v_rcp_f32 v208, v208
    v_rcp_f32 v209, v209
    v_rcp_f32 v210, v210
    v_rcp_f32 v211, v211
    v_rcp_f32 v212, v212
    v_rcp_f32 v213, v213
    v_rcp_f32 v214, v214
    v_rcp_f32 v215, v215
    v_pk_mul_f32 v[160:161], v[160:161], v[208:209]
    v_pk_mul_f32 v[162:163], v[162:163], v[210:211]
    v_pk_mul_f32 v[164:165], v[164:165], v[212:213]
    v_pk_mul_f32 v[166:167], v[166:167], v[214:215]
    v_cvt_pk_bf16_f32 v32, v160, v161
    v_cvt_pk_bf16_f32 v33, v162, v163
    v_cvt_pk_bf16_f32 v34, v164, v165
    v_cvt_pk_bf16_f32 v35, v166, v167
    buffer_store_dwordx4 v[32:35], v8, s[68:71], s4 offen offset:0 sc1
    v_pk_add_f32 v[168:169], v[168:169], v[216:217]
    v_pk_add_f32 v[170:171], v[170:171], v[218:219]
    v_pk_add_f32 v[172:173], v[172:173], v[220:221]
    v_pk_add_f32 v[174:175], v[174:175], v[222:223]
    v_exp_f32 v216, v168
    v_exp_f32 v217, v169
    v_exp_f32 v218, v170
    v_exp_f32 v219, v171
    v_exp_f32 v220, v172
    v_exp_f32 v221, v173
    v_exp_f32 v222, v174
    v_exp_f32 v223, v175
    v_pk_fma_f32 v[216:217], v[216:217], s[98:99], s[98:99] op_sel_hi:[1,0,0]
    v_pk_fma_f32 v[218:219], v[218:219], s[98:99], s[98:99] op_sel_hi:[1,0,0]
    v_pk_fma_f32 v[220:221], v[220:221], s[98:99], s[98:99] op_sel_hi:[1,0,0]
    v_pk_fma_f32 v[222:223], v[222:223], s[98:99], s[98:99] op_sel_hi:[1,0,0]
    v_rcp_f32 v216, v216
    v_rcp_f32 v217, v217
    v_rcp_f32 v218, v218
    v_rcp_f32 v219, v219
    v_rcp_f32 v220, v220
    v_rcp_f32 v221, v221
    v_rcp_f32 v222, v222
    v_rcp_f32 v223, v223
    v_pk_mul_f32 v[168:169], v[168:169], v[216:217]
    v_pk_mul_f32 v[170:171], v[170:171], v[218:219]
    v_pk_mul_f32 v[172:173], v[172:173], v[220:221]
    v_pk_mul_f32 v[174:175], v[174:175], v[222:223]
    v_cvt_pk_bf16_f32 v36, v168, v169
    v_cvt_pk_bf16_f32 v37, v170, v171
    v_cvt_pk_bf16_f32 v38, v172, v173
    v_cvt_pk_bf16_f32 v39, v174, v175
    buffer_store_dwordx4 v[36:39], v8, s[68:71], s4 offen offset:1024 sc1
    s_add_u32 s4, s4, 4096
L_gskip_31:
    s_waitcnt vmcnt(0)
    s_mov_b64 exec, 1
    ds_add_rtn_u32 v1, v9, v2 offset:32
    s_lshl_b32 s4, s3, 2
    s_add_u32 s4, s4, s7
    s_waitcnt lgkmcnt(0)
    v_readfirstlane_b32 s8, v1
    s_cmp_eq_u32 s8, 3
    s_cselect_b32 s4, s4, 2147418112
    buffer_store_dword v15, off, s[64:67], s4 sc1
    s_mov_b64 exec, -1
    s_sub_u32 s9, s13, s25
    v_add_u32 v6, s9, v124
    v_add_u32 v11, s9, v125
    v_add_u32 v12, s9, v126
    v_add_u32 v119, s9, v127
    v_lshrrev_b32 v118, 3, v0
    s_lshl2_add_u32 s9, s11, s12
    s_lshl3_add_u32 s9, s9, 16
    v_add_u32 v118, s9, v118
    v_mul_u32_u24 v116, 272, v118
    v_lshlrev_b32 v117, 10, v118
    v_and_b32 v118, 7, v0
    v_lshl_add_u32 v116, v118, 5, v116
    v_add_u32 v116, 107520, v116
    v_lshl_add_u32 v117, v118, 4, v117
    s_lshl_b32 s20, s27, 16
    s_lshl_b32 s9, s3, 7
    s_add_u32 s20, s20, s9
    buffer_load_dwordx4 v[112:115], v117, s[28:31], s20 offen
    s_lshl_b32 s9, s11, 15
    s_sub_u32 s9, s9, s13
    v_lshrrev_b32 v118, 5, v0
    v_lshl_add_u32 v118, v118, 10, s9
    s_branch L_spf_47
L_sp_45:
    s_sleep 2
L_spf_47:
    ds_read_b32 v1, v9 offset:32
    s_sub_u32 s10, s10, 1
    s_cmp_lt_i32 s10, 0
    s_cbranch_scc1 L_spd_46
    s_waitcnt lgkmcnt(0)
    v_readfirstlane_b32 s9, v1
    s_cmp_lt_u32 s9, 4
    s_cbranch_scc1 L_sp_45
L_spd_46:
    s_add_u32 m0, s13, 0
    s_nop 0
    buffer_load_dwordx4 v120, s[52:55], s40 offen offset:0 lds
    buffer_load_dwordx4 v121, s[52:55], s40 offen offset:1024 lds
    s_add_u32 s40, s40, 16384
    s_add_u32 m0, s13, 2048
    s_nop 0
    buffer_load_dwordx4 v120, s[52:55], s40 offen offset:0 lds
    buffer_load_dwordx4 v121, s[52:55], s40 offen offset:1024 lds
    s_add_u32 s40, s40, 16384
    s_cmp_ge_u32 s40, s41
    s_cselect_b32 s9, 360448, 0
    s_sub_u32 s40, s40, s9
    s_waitcnt vmcnt(4)
    s_add_u32 m0, s13, 4096
    s_nop 0
    buffer_load_dwordx4 v120, s[52:55], s40 offen offset:0 lds
    buffer_load_dwordx4 v121, s[52:55], s40 offen offset:1024 lds
    s_add_u32 s40, s40, 16384
    s_waitcnt vmcnt(4)
    s_add_u32 m0, s13, 6144
    s_nop 0
    buffer_load_dwordx4 v120, s[52:55], s40 offen offset:0 lds
    buffer_load_dwordx4 v121, s[52:55], s40 offen offset:1024 lds
    s_add_u32 s40, s40, 16384
    s_cmp_ge_u32 s40, s41
    s_cselect_b32 s9, 360448, 0
    s_sub_u32 s40, s40, s9
    s_waitcnt vmcnt(4)
    s_add_u32 m0, s13, 8192
    s_nop 0
    buffer_load_dwordx4 v120, s[52:55], s40 offen offset:0 lds
    buffer_load_dwordx4 v121, s[52:55], s40 offen offset:1024 lds
    s_add_u32 s40, s40, 16384
    s_waitcnt vmcnt(4)
    s_add_u32 m0, s13, 10240
    s_nop 0
    buffer_load_dwordx4 v120, s[52:55], s40 offen offset:0 lds
    buffer_load_dwordx4 v121, s[52:55], s40 offen offset:1024 lds
    s_add_u32 s40, s40, 16384
    s_cmp_ge_u32 s40, s41
    s_cselect_b32 s9, 360448, 0
    s_sub_u32 s40, s40, s9
    s_cmp_lg_u32 s8, 3
    s_cbranch_scc1 L_ho_51
    v_and_b32 v4, 7, v0
    v_lshlrev_b32 v4, 2, v4
    s_branch L_hf_49
L_hp_48:
    s_sleep 4
L_hf_49:
    buffer_load_dword v5, v4, s[64:67], s7 offen sc1
    s_waitcnt vmcnt(0)
    s_sub_u32 s10, s10, 1
    s_cmp_lt_i32 s10, 0
    s_cbranch_scc1 L_hd_50
    v_cmp_eq_u32 vcc, v15, v5
    s_cmp_eq_u64 vcc, exec
    s_cbranch_scc0 L_hp_48
L_hd_50:
    s_mov_b64 exec, 1
    ds_add_u32 v9, v2 offset:36
    s_mov_b64 exec, -1
    s_branch L_hj_52
L_ho_51:
    s_branch L_spf_55
L_sp_53:
    s_sleep 6
L_spf_55:
    ds_read_b32 v1, v9 offset:36
    s_sub_u32 s10, s10, 1
    s_cmp_lt_i32 s10, 0
    s_cbranch_scc1 L_spd_54
    s_waitcnt lgkmcnt(0)
    v_readfirstlane_b32 s9, v1
    s_cmp_lt_u32 s9, 1
    s_cbranch_scc1 L_sp_53
L_spd_54:
L_hj_52:
    s_waitcnt vmcnt(4)
    buffer_load_dwordx4 v[216:219], v123, s[68:71], s42 offen offset:0 sc1
    buffer_load_dwordx4 v[220:223], v123, s[68:71], s42 offen offset:1024 sc1
    s_waitcnt vmcnt(4)
    buffer_load_dwordx4 v[208:211], v122, s[68:71], s42 offen offset:0 sc1
    buffer_load_dwordx4 v[212:215], v122, s[68:71], s42 offen offset:1024 sc1
    s_add_u32 s42, s42, 4096
    s_cmp_ge_u32 s42, s43
    s_cselect_b32 s9, 45056, 0
    s_sub_u32 s42, s42, s9
    s_waitcnt vmcnt(4)
    buffer_load_dwordx4 v[232:235], v123, s[68:71], s42 offen offset:0 sc1
    buffer_load_dwordx4 v[236:239], v123, s[68:71], s42 offen offset:1024 sc1
    s_waitcnt vmcnt(4)
    buffer_load_dwordx4 v[224:227], v122, s[68:71], s42 offen offset:0 sc1
    buffer_load_dwordx4 v[228:231], v122, s[68:71], s42 offen offset:1024 sc1
    s_add_u32 s42, s42, 4096
    s_cmp_ge_u32 s42, s43
    s_cselect_b32 s9, 45056, 0
    s_sub_u32 s42, s42, s9
    s_waitcnt vmcnt(4)
    buffer_load_dwordx4 v[248:251], v123, s[68:71], s42 offen offset:0 sc1
    buffer_load_dwordx4 v[252:255], v123, s[68:71], s42 offen offset:1024 sc1
    s_waitcnt vmcnt(4)
    buffer_load_dwordx4 v[240:243], v122, s[68:71], s42 offen offset:0 sc1
    buffer_load_dwordx4 v[244:247], v122, s[68:71], s42 offen offset:1024 sc1
    s_add_u32 s42, s42, 4096
    s_cmp_ge_u32 s42, s43
    s_cselect_b32 s9, 45056, 0
    s_sub_u32 s42, s42, s9
    s_or_b32 s15, s3, s26
    s_cselect_b32 s15, 2147418112, 0
    s_mov_b64 exec, 1
    v_mov_b32 v7, 1
    buffer_atomic_add v7, off, s[56:59], s15 sc0 sc1
    s_mov_b64 exec, -1
    s_lshl_b32 s4, s27, 16
    s_lshl_b32 s5, s12, 15
    s_add_u32 s4, s4, s5
    s_lshl_b32 s5, s11, 14
    s_add_u32 s4, s4, s5
    s_add_u32 s4, s4, 131072
    s_lshl_b32 s5, s14, 10
    s_xor_b32 s4, s4, s5
    s_xor_b32 s5, s4, 4096
    s_xor_b32 s6, s4, 8192
    s_xor_b32 s7, s4, 12288
    v_and_b32 v16, 15, v0
    v_lshrrev_b32 v17, 4, v0
    v_mul_u32_u24 v4, 272, v16
    v_lshl_add_u32 v4, v17, 4, v4
    s_mul_i32 s9, s12, 8704
    s_mul_i32 s8, s11, 17408
    s_add_u32 s8, s8, s9
    s_add_u32 s8, s8, 107520
    v_add_u32 v4, s8, v4
    v_lshlrev_b32 v5, 4, v16
    v_lshl_add_u32 v5, v17, 9, v5
    ds_read_b64_tr_b16 v[80:81], v124 offset:0
    ds_read_b64_tr_b16 v[82:83], v124 offset:2048
    ds_read_b64_tr_b16 v[84:85], v125 offset:0
    ds_read_b64_tr_b16 v[86:87], v125 offset:2048
    ds_read_b64_tr_b16 v[88:89], v126 offset:0
    ds_read_b64_tr_b16 v[90:91], v126 offset:2048
    ds_read_b64_tr_b16 v[92:93], v127 offset:0
    ds_read_b64_tr_b16 v[94:95], v127 offset:2048
    s_setprio 0
    s_waitcnt lgkmcnt(0)
    v_mfma_f32_16x16x32_bf16 v[48:51], v[80:83], v[216:219], 0
    v_mfma_f32_16x16x32_bf16 v[52:55], v[80:83], v[220:223], 0
    ds_read_b64_tr_b16 v[96:97], v124 offset:4096
    ds_read_b64_tr_b16 v[98:99], v124 offset:6144
    v_mfma_f32_16x16x32_bf16 v[56:59], v[84:87], v[216:219], 0
    v_mfma_f32_16x16x32_bf16 v[60:63], v[84:87], v[220:223], 0
    ds_read_b64_tr_b16 v[100:101], v125 offset:4096
    ds_read_b64_tr_b16 v[102:103], v125 offset:6144
    v_mfma_f32_16x16x32_bf16 v[64:67], v[88:91], v[216:219], 0
    v_mfma_f32_16x16x32_bf16 v[68:71], v[88:91], v[220:223], 0
    v_mfma_f32_16x16x32_bf16 v[72:75], v[92:95], v[216:219], 0
    v_mfma_f32_16x16x32_bf16 v[76:79], v[92:95], v[220:223], 0
    ds_read_b64_tr_b16 v[104:105], v126 offset:4096
    ds_read_b64_tr_b16 v[106:107], v126 offset:6144
    v_mfma_f32_16x16x32_bf16 v[16:19], v[80:83], v[208:211], 0
    v_mfma_f32_16x16x32_bf16 v[20:23], v[80:83], v[212:215], 0
    ds_read_b64_tr_b16 v[108:109], v127 offset:4096
    ds_read_b64_tr_b16 v[110:111], v127 offset:6144
    v_mfma_f32_16x16x32_bf16 v[24:27], v[84:87], v[208:211], 0
    v_mfma_f32_16x16x32_bf16 v[28:31], v[84:87], v[212:215], 0
    v_mfma_f32_16x16x32_bf16 v[32:35], v[88:91], v[208:211], 0
    v_mfma_f32_16x16x32_bf16 v[36:39], v[88:91], v[212:215], 0
    v_mfma_f32_16x16x32_bf16 v[40:43], v[92:95], v[208:211], 0
    v_mfma_f32_16x16x32_bf16 v[44:47], v[92:95], v[212:215], 0
    s_waitcnt lgkmcnt(0)
    s_waitcnt vmcnt(5)
    v_mfma_f32_16x16x32_bf16 v[48:51], v[96:99], v[232:235], v[48:51]
    v_mfma_f32_16x16x32_bf16 v[52:55], v[96:99], v[236:239], v[52:55]
    s_waitcnt vmcnt(4)
    s_add_u32 m0, s25, 0
    s_nop 0
    buffer_load_dwordx4 v120, s[52:55], s40 offen offset:0 lds
    buffer_load_dwordx4 v121, s[52:55], s40 offen offset:1024 lds
    s_add_u32 s40, s40, 16384
    s_waitcnt vmcnt(4)
    s_add_u32 m0, s25, 2048
    s_nop 0
    buffer_load_dwordx4 v120, s[52:55], s40 offen offset:0 lds
    buffer_load_dwordx4 v121, s[52:55], s40 offen offset:1024 lds
    s_add_u32 s40, s40, 16384
    s_cmp_ge_u32 s40, s41
    s_cselect_b32 s9, 360448, 0
    s_sub_u32 s40, s40, s9
    v_mfma_f32_16x16x32_bf16 v[56:59], v[100:103], v[232:235], v[56:59]
    v_mfma_f32_16x16x32_bf16 v[60:63], v[100:103], v[236:239], v[60:63]
    s_waitcnt vmcnt(4)
    buffer_load_dwordx4 v[216:219], v123, s[68:71], s42 offen offset:0 sc1
    buffer_load_dwordx4 v[220:223], v123, s[68:71], s42 offen offset:1024 sc1
    v_mfma_f32_16x16x32_bf16 v[64:67], v[104:107], v[232:235], v[64:67]
    v_mfma_f32_16x16x32_bf16 v[68:71], v[104:107], v[236:239], v[68:71]
    s_waitcnt vmcnt(4)
    buffer_load_dwordx4 v[208:211], v122, s[68:71], s42 offen offset:0 sc1
    buffer_load_dwordx4 v[212:215], v122, s[68:71], s42 offen offset:1024 sc1
    s_add_u32 s42, s42, 4096
    s_cmp_ge_u32 s42, s43
    s_cselect_b32 s9, 45056, 0
    s_sub_u32 s42, s42, s9
    v_mfma_f32_16x16x32_bf16 v[72:75], v[108:111], v[232:235], v[72:75]
    v_mfma_f32_16x16x32_bf16 v[76:79], v[108:111], v[236:239], v[76:79]
    ds_read_b64_tr_b16 v[80:81], v6 offset:0
    ds_read_b64_tr_b16 v[82:83], v6 offset:2048
    v_mfma_f32_16x16x32_bf16 v[16:19], v[96:99], v[224:227], v[16:19]
    v_mfma_f32_16x16x32_bf16 v[20:23], v[96:99], v[228:231], v[20:23]
    ds_read_b64_tr_b16 v[84:85], v11 offset:0
    ds_read_b64_tr_b16 v[86:87], v11 offset:2048
    v_mfma_f32_16x16x32_bf16 v[24:27], v[100:103], v[224:227], v[24:27]
    v_mfma_f32_16x16x32_bf16 v[28:31], v[100:103], v[228:231], v[28:31]
    ds_read_b64_tr_b16 v[88:89], v12 offset:0
    ds_read_b64_tr_b16 v[90:91], v12 offset:2048
    v_mfma_f32_16x16x32_bf16 v[32:35], v[104:107], v[224:227], v[32:35]
    v_mfma_f32_16x16x32_bf16 v[36:39], v[104:107], v[228:231], v[36:39]
    ds_read_b64_tr_b16 v[92:93], v119 offset:0
    ds_read_b64_tr_b16 v[94:95], v119 offset:2048
    v_mfma_f32_16x16x32_bf16 v[40:43], v[108:111], v[224:227], v[40:43]
    v_mfma_f32_16x16x32_bf16 v[44:47], v[108:111], v[228:231], v[44:47]
    s_waitcnt lgkmcnt(0)
    v_mfma_f32_16x16x32_bf16 v[48:51], v[80:83], v[248:251], v[48:51]
    v_mfma_f32_16x16x32_bf16 v[52:55], v[80:83], v[252:255], v[52:55]
    s_waitcnt vmcnt(4)
    buffer_load_dwordx4 v[232:235], v123, s[68:71], s42 offen offset:0 sc1
    buffer_load_dwordx4 v[236:239], v123, s[68:71], s42 offen offset:1024 sc1
    v_mfma_f32_16x16x32_bf16 v[56:59], v[84:87], v[248:251], v[56:59]
    v_mfma_f32_16x16x32_bf16 v[60:63], v[84:87], v[252:255], v[60:63]
    s_waitcnt vmcnt(4)
    buffer_load_dwordx4 v[224:227], v122, s[68:71], s42 offen offset:0 sc1
    buffer_load_dwordx4 v[228:231], v122, s[68:71], s42 offen offset:1024 sc1
    s_add_u32 s42, s42, 4096
    s_cmp_ge_u32 s42, s43
    s_cselect_b32 s9, 45056, 0
    s_sub_u32 s42, s42, s9
    v_mfma_f32_16x16x32_bf16 v[64:67], v[88:91], v[248:251], v[64:67]
    v_mfma_f32_16x16x32_bf16 v[68:71], v[88:91], v[252:255], v[68:71]
    ds_read_b64_tr_b16 v[96:97], v6 offset:4096
    ds_read_b64_tr_b16 v[98:99], v6 offset:6144
    v_mfma_f32_16x16x32_bf16 v[72:75], v[92:95], v[248:251], v[72:75]
    v_mfma_f32_16x16x32_bf16 v[76:79], v[92:95], v[252:255], v[76:79]
    ds_read_b64_tr_b16 v[100:101], v11 offset:4096
    ds_read_b64_tr_b16 v[102:103], v11 offset:6144
    v_mfma_f32_16x16x32_bf16 v[16:19], v[80:83], v[240:243], v[16:19]
    v_mfma_f32_16x16x32_bf16 v[20:23], v[80:83], v[244:247], v[20:23]
    ds_read_b64_tr_b16 v[104:105], v12 offset:4096
    ds_read_b64_tr_b16 v[106:107], v12 offset:6144
    v_mfma_f32_16x16x32_bf16 v[24:27], v[84:87], v[240:243], v[24:27]
    v_mfma_f32_16x16x32_bf16 v[28:31], v[84:87], v[244:247], v[28:31]
    ds_read_b64_tr_b16 v[108:109], v119 offset:4096
    ds_read_b64_tr_b16 v[110:111], v119 offset:6144
    v_mfma_f32_16x16x32_bf16 v[32:35], v[88:91], v[240:243], v[32:35]
    v_mfma_f32_16x16x32_bf16 v[36:39], v[88:91], v[244:247], v[36:39]
    v_mfma_f32_16x16x32_bf16 v[40:43], v[92:95], v[240:243], v[40:43]
    v_mfma_f32_16x16x32_bf16 v[44:47], v[92:95], v[244:247], v[44:47]
    s_waitcnt lgkmcnt(0)
    s_waitcnt vmcnt(4)
    v_mfma_f32_16x16x32_bf16 v[48:51], v[96:99], v[216:219], v[48:51]
    v_mfma_f32_16x16x32_bf16 v[52:55], v[96:99], v[220:223], v[52:55]
    s_add_u32 m0, s25, 4096
    s_nop 0
    buffer_load_dwordx4 v120, s[52:55], s40 offen offset:0 lds
    buffer_load_dwordx4 v121, s[52:55], s40 offen offset:1024 lds
    s_add_u32 s40, s40, 16384
    s_waitcnt vmcnt(4)
    s_add_u32 m0, s25, 6144
    s_nop 0
    buffer_load_dwordx4 v120, s[52:55], s40 offen offset:0 lds
    buffer_load_dwordx4 v121, s[52:55], s40 offen offset:1024 lds
    s_add_u32 s40, s40, 16384
    s_cmp_ge_u32 s40, s41
    s_cselect_b32 s9, 360448, 0
    s_sub_u32 s40, s40, s9
    v_mfma_f32_16x16x32_bf16 v[56:59], v[100:103], v[216:219], v[56:59]
    v_mfma_f32_16x16x32_bf16 v[60:63], v[100:103], v[220:223], v[60:63]
    s_waitcnt vmcnt(4)
    buffer_load_dwordx4 v[248:251], v123, s[68:71], s42 offen offset:0 sc1
    buffer_load_dwordx4 v[252:255], v123, s[68:71], s42 offen offset:1024 sc1
L_pgg3:
    s_cbranch_execz L_rtg3
    v_mfma_f32_16x16x32_bf16 v[64:67], v[104:107], v[216:219], v[64:67]
    v_mfma_f32_16x16x32_bf16 v[68:71], v[104:107], v[220:223], v[68:71]
    s_waitcnt vmcnt(4)
    buffer_load_dwordx4 v[240:243], v122, s[68:71], s42 offen offset:0 sc1
    buffer_load_dwordx4 v[244:247], v122, s[68:71], s42 offen offset:1024 sc1
    s_add_u32 s42, s42, 4096
    s_cmp_ge_u32 s42, s43
    s_cselect_b32 s9, 45056, 0
    s_sub_u32 s42, s42, s9
    v_mfma_f32_16x16x32_bf16 v[72:75], v[108:111], v[216:219], v[72:75]
    v_mfma_f32_16x16x32_bf16 v[76:79], v[108:111], v[220:223], v[76:79]
    ds_read_b64_tr_b16 v[80:81], v6 offset:8192
    ds_read_b64_tr_b16 v[82:83], v6 offset:10240
    v_mfma_f32_16x16x32_bf16 v[16:19], v[96:99], v[208:211], v[16:19]
    v_mfma_f32_16x16x32_bf16 v[20:23], v[96:99], v[212:215], v[20:23]
    ds_read_b64_tr_b16 v[84:85], v11 offset:8192
    ds_read_b64_tr_b16 v[86:87], v11 offset:10240
    v_mfma_f32_16x16x32_bf16 v[24:27], v[100:103], v[208:211], v[24:27]
    v_mfma_f32_16x16x32_bf16 v[28:31], v[100:103], v[212:215], v[28:31]
    ds_read_b64_tr_b16 v[88:89], v12 offset:8192
    ds_read_b64_tr_b16 v[90:91], v12 offset:10240
    v_mfma_f32_16x16x32_bf16 v[32:35], v[104:107], v[208:211], v[32:35]
    v_mfma_f32_16x16x32_bf16 v[36:39], v[104:107], v[212:215], v[36:39]
    ds_read_b64_tr_b16 v[92:93], v119 offset:8192
    ds_read_b64_tr_b16 v[94:95], v119 offset:10240
    v_mfma_f32_16x16x32_bf16 v[40:43], v[108:111], v[208:211], v[40:43]
    v_mfma_f32_16x16x32_bf16 v[44:47], v[108:111], v[212:215], v[44:47]
    s_waitcnt lgkmcnt(0)
    v_mfma_f32_16x16x32_bf16 v[48:51], v[80:83], v[232:235], v[48:51]
    v_mfma_f32_16x16x32_bf16 v[52:55], v[80:83], v[236:239], v[52:55]
    s_waitcnt vmcnt(4)
    buffer_load_dwordx4 v[216:219], v123, s[68:71], s42 offen offset:0 sc1
    buffer_load_dwordx4 v[220:223], v123, s[68:71], s42 offen offset:1024 sc1
    s_waitcnt vmcnt(4)
    buffer_load_dwordx4 v[208:211], v122, s[68:71], s42 offen offset:0 sc1
    buffer_load_dwordx4 v[212:215], v122, s[68:71], s42 offen offset:1024 sc1
    s_add_u32 s42, s42, 4096
    s_cmp_ge_u32 s42, s43
    s_cselect_b32 s9, 45056, 0
    s_sub_u32 s42, s42, s9
    v_mfma_f32_16x16x32_bf16 v[56:59], v[84:87], v[232:235], v[56:59]
    v_mfma_f32_16x16x32_bf16 v[60:63], v[84:87], v[236:239], v[60:63]
    s_setprio 2
    s_mov_b64 exec, 1
    v_readfirstlane_b32 s9, v7
    s_mov_b32 s15, 9404416
    s_cmp_eq_u32 s9, 31
    s_cselect_b32 s15, s15, 2147418112
    buffer_store_dword v15, off, s[64:67], s15 sc1
    s_mov_b64 exec, -1
    s_setprio 0
    v_mfma_f32_16x16x32_bf16 v[64:67], v[88:91], v[232:235], v[64:67]
    v_mfma_f32_16x16x32_bf16 v[68:71], v[88:91], v[236:239], v[68:71]
    s_setprio 2
    v_add_u32 v6, v118, v6
    v_add_u32 v11, v118, v11
    v_add_u32 v12, v118, v12
    v_add_u32 v119, v118, v119
    s_setprio 0
    v_mfma_f32_16x16x32_bf16 v[72:75], v[92:95], v[232:235], v[72:75]
    v_mfma_f32_16x16x32_bf16 v[76:79], v[92:95], v[236:239], v[76:79]
    s_mov_b64 exec, 1
    ds_add_u32 v9, v2 offset:48
    s_mov_b64 exec, -1
    v_mfma_f32_16x16x32_bf16 v[16:19], v[80:83], v[224:227], v[16:19]
    v_mfma_f32_16x16x32_bf16 v[20:23], v[80:83], v[228:231], v[20:23]
    ds_read_b64_tr_b16 v[96:97], v124 offset:0
    ds_read_b64_tr_b16 v[98:99], v124 offset:2048
    v_mfma_f32_16x16x32_bf16 v[24:27], v[84:87], v[224:227], v[24:27]
    v_mfma_f32_16x16x32_bf16 v[28:31], v[84:87], v[228:231], v[28:31]
    ds_read_b64_tr_b16 v[100:101], v125 offset:0
    ds_read_b64_tr_b16 v[102:103], v125 offset:2048
    ds_read_b64_tr_b16 v[104:105], v126 offset:0
    ds_read_b64_tr_b16 v[106:107], v126 offset:2048
    v_mfma_f32_16x16x32_bf16 v[32:35], v[88:91], v[224:227], v[32:35]
    v_mfma_f32_16x16x32_bf16 v[36:39], v[88:91], v[228:231], v[36:39]
    ds_read_b64_tr_b16 v[108:109], v127 offset:0
    ds_read_b64_tr_b16 v[110:111], v127 offset:2048
    v_mfma_f32_16x16x32_bf16 v[40:43], v[92:95], v[224:227], v[40:43]
    v_mfma_f32_16x16x32_bf16 v[44:47], v[92:95], v[228:231], v[44:47]
    s_waitcnt lgkmcnt(0)
    s_waitcnt vmcnt(5)
    v_mfma_f32_16x16x32_bf16 v[48:51], v[96:99], v[248:251], v[48:51]
    v_mfma_f32_16x16x32_bf16 v[52:55], v[96:99], v[252:255], v[52:55]
    s_waitcnt vmcnt(4)
    s_add_u32 m0, s25, 0
    s_nop 0
    buffer_load_dwordx4 v120, s[52:55], s40 offen offset:0 lds
    buffer_load_dwordx4 v121, s[52:55], s40 offen offset:1024 lds
    s_add_u32 s40, s40, 16384
    s_waitcnt vmcnt(4)
    s_add_u32 m0, s25, 2048
    s_nop 0
    buffer_load_dwordx4 v120, s[52:55], s40 offen offset:0 lds
    buffer_load_dwordx4 v121, s[52:55], s40 offen offset:1024 lds
    s_add_u32 s40, s40, 16384
    s_cmp_ge_u32 s40, s41
    s_cselect_b32 s9, 360448, 0
    s_sub_u32 s40, s40, s9
    v_mfma_f32_16x16x32_bf16 v[56:59], v[100:103], v[248:251], v[56:59]
    v_mfma_f32_16x16x32_bf16 v[60:63], v[100:103], v[252:255], v[60:63]
    s_waitcnt vmcnt(4)
    buffer_load_dwordx4 v[232:235], v123, s[68:71], s42 offen offset:0 sc1
    buffer_load_dwordx4 v[236:239], v123, s[68:71], s42 offen offset:1024 sc1
    s_waitcnt vmcnt(4)
    buffer_load_dwordx4 v[224:227], v122, s[68:71], s42 offen offset:0 sc1
    buffer_load_dwordx4 v[228:231], v122, s[68:71], s42 offen offset:1024 sc1
    s_add_u32 s42, s42, 4096
    s_cmp_ge_u32 s42, s43
    s_cselect_b32 s9, 45056, 0
    s_sub_u32 s42, s42, s9
    v_mfma_f32_16x16x32_bf16 v[64:67], v[104:107], v[248:251], v[64:67]
    v_mfma_f32_16x16x32_bf16 v[68:71], v[104:107], v[252:255], v[68:71]
    ds_read_b64_tr_b16 v[128:129], v6 offset:0
    ds_read_b64_tr_b16 v[130:131], v6 offset:1024
    ds_read_b64_tr_b16 v[132:133], v11 offset:0
    ds_read_b64_tr_b16 v[134:135], v11 offset:1024
    v_mfma_f32_16x16x32_bf16 v[72:75], v[108:111], v[248:251], v[72:75]
    v_mfma_f32_16x16x32_bf16 v[76:79], v[108:111], v[252:255], v[76:79]
    ds_read_b64_tr_b16 v[136:137], v12 offset:0
    ds_read_b64_tr_b16 v[138:139], v12 offset:1024
    v_mfma_f32_16x16x32_bf16 v[16:19], v[96:99], v[240:243], v[16:19]
    v_mfma_f32_16x16x32_bf16 v[20:23], v[96:99], v[244:247], v[20:23]
    ds_read_b64_tr_b16 v[140:141], v119 offset:0
    ds_read_b64_tr_b16 v[142:143], v119 offset:1024
    ds_read_b64_tr_b16 v[144:145], v6 offset:4096
    ds_read_b64_tr_b16 v[146:147], v6 offset:5120
    v_mfma_f32_16x16x32_bf16 v[24:27], v[100:103], v[240:243], v[24:27]
    v_mfma_f32_16x16x32_bf16 v[28:31], v[100:103], v[244:247], v[28:31]
    ds_read_b64_tr_b16 v[80:81], v124 offset:4096
    ds_read_b64_tr_b16 v[82:83], v124 offset:6144
    ds_read_b64_tr_b16 v[84:85], v125 offset:4096
    ds_read_b64_tr_b16 v[86:87], v125 offset:6144
    v_mfma_f32_16x16x32_bf16 v[32:35], v[104:107], v[240:243], v[32:35]
    v_mfma_f32_16x16x32_bf16 v[36:39], v[104:107], v[244:247], v[36:39]
    ds_read_b64_tr_b16 v[88:89], v126 offset:4096
    ds_read_b64_tr_b16 v[90:91], v126 offset:6144
    ds_read_b64_tr_b16 v[92:93], v127 offset:4096
    ds_read_b64_tr_b16 v[94:95], v127 offset:6144
    v_mfma_f32_16x16x32_bf16 v[40:43], v[108:111], v[240:243], v[40:43]
    v_mfma_f32_16x16x32_bf16 v[44:47], v[108:111], v[244:247], v[44:47]
    s_waitcnt lgkmcnt(0)
    v_mfma_f32_16x16x32_bf16 v[48:51], v[80:83], v[216:219], v[48:51]
    v_mfma_f32_16x16x32_bf16 v[52:55], v[80:83], v[220:223], v[52:55]
    s_waitcnt vmcnt(4)
    s_add_u32 m0, s25, 4096
    s_nop 0
    buffer_load_dwordx4 v120, s[52:55], s40 offen offset:0 lds
    buffer_load_dwordx4 v121, s[52:55], s40 offen offset:1024 lds
    s_add_u32 s40, s40, 16384
    s_waitcnt vmcnt(4)
    s_add_u32 m0, s25, 6144
    s_nop 0
    buffer_load_dwordx4 v120, s[52:55], s40 offen offset:0 lds
    buffer_load_dwordx4 v121, s[52:55], s40 offen offset:1024 lds
    s_add_u32 s40, s40, 16384
    s_cmp_ge_u32 s40, s41
    s_cselect_b32 s9, 360448, 0
    s_sub_u32 s40, s40, s9
    v_mfma_f32_16x16x32_bf16 v[56:59], v[84:87], v[216:219], v[56:59]
    v_mfma_f32_16x16x32_bf16 v[60:63], v[84:87], v[220:223], v[60:63]
    s_waitcnt vmcnt(4)
    buffer_load_dwordx4 v[248:251], v123, s[68:71], s42 offen offset:0 sc1
    buffer_load_dwordx4 v[252:255], v123, s[68:71], s42 offen offset:1024 sc1
    s_waitcnt vmcnt(4)
    buffer_load_dwordx4 v[240:243], v122, s[68:71], s42 offen offset:0 sc1
    buffer_load_dwordx4 v[244:247], v122, s[68:71], s42 offen offset:1024 sc1
    s_add_u32 s42, s42, 4096
    s_cmp_ge_u32 s42, s43
    s_cselect_b32 s9, 45056, 0
    s_sub_u32 s42, s42, s9
    v_mfma_f32_16x16x32_bf16 v[64:67], v[88:91], v[216:219], v[64:67]
    v_mfma_f32_16x16x32_bf16 v[68:71], v[88:91], v[220:223], v[68:71]
    ds_read_b64_tr_b16 v[148:149], v11 offset:4096
    ds_read_b64_tr_b16 v[150:151], v11 offset:5120
    ds_read_b64_tr_b16 v[152:153], v12 offset:4096
    ds_read_b64_tr_b16 v[154:155], v12 offset:5120
    v_mfma_f32_16x16x32_bf16 v[72:75], v[92:95], v[216:219], v[72:75]
    v_mfma_f32_16x16x32_bf16 v[76:79], v[92:95], v[220:223], v[76:79]
    ds_read_b64_tr_b16 v[156:157], v119 offset:4096
    ds_read_b64_tr_b16 v[158:159], v119 offset:5120
    v_mfma_f32_16x16x32_bf16 v[16:19], v[80:83], v[208:211], v[16:19]
    v_mfma_f32_16x16x32_bf16 v[20:23], v[80:83], v[212:215], v[20:23]
    ds_read_b64_tr_b16 v[160:161], v6 offset:8192
    ds_read_b64_tr_b16 v[162:163], v6 offset:9216
    ds_read_b64_tr_b16 v[164:165], v11 offset:8192
    ds_read_b64_tr_b16 v[166:167], v11 offset:9216
    v_mfma_f32_16x16x32_bf16 v[24:27], v[84:87], v[208:211], v[24:27]
    v_mfma_f32_16x16x32_bf16 v[28:31], v[84:87], v[212:215], v[28:31]
    ds_read_b64_tr_b16 v[96:97], v124 offset:0
    ds_read_b64_tr_b16 v[98:99], v124 offset:2048
    ds_read_b64_tr_b16 v[100:101], v125 offset:0
    ds_read_b64_tr_b16 v[102:103], v125 offset:2048
    v_mfma_f32_16x16x32_bf16 v[32:35], v[88:91], v[208:211], v[32:35]
    v_mfma_f32_16x16x32_bf16 v[36:39], v[88:91], v[212:215], v[36:39]
    ds_read_b64_tr_b16 v[104:105], v126 offset:0
    ds_read_b64_tr_b16 v[106:107], v126 offset:2048
    ds_read_b64_tr_b16 v[108:109], v127 offset:0
    ds_read_b64_tr_b16 v[110:111], v127 offset:2048
    v_mfma_f32_16x16x32_bf16 v[40:43], v[92:95], v[208:211], v[40:43]
    v_mfma_f32_16x16x32_bf16 v[44:47], v[92:95], v[212:215], v[44:47]
    s_waitcnt lgkmcnt(0)
    v_mfma_f32_16x16x32_bf16 v[48:51], v[96:99], v[232:235], v[48:51]
    v_mfma_f32_16x16x32_bf16 v[52:55], v[96:99], v[236:239], v[52:55]
    s_waitcnt vmcnt(4)
    s_add_u32 m0, s25, 0
    s_nop 0
    buffer_load_dwordx4 v120, s[52:55], s40 offen offset:0 lds
    buffer_load_dwordx4 v121, s[52:55], s40 offen offset:1024 lds
    s_add_u32 s40, s40, 16384
    s_waitcnt vmcnt(4)
    s_add_u32 m0, s25, 2048
    s_nop 0
    buffer_load_dwordx4 v120, s[52:55], s40 offen offset:0 lds
    buffer_load_dwordx4 v121, s[52:55], s40 offen offset:1024 lds
    s_add_u32 s40, s40, 16384
    s_cmp_ge_u32 s40, s41
    s_cselect_b32 s9, 360448, 0
    s_sub_u32 s40, s40, s9
    v_mfma_f32_16x16x32_bf16 v[56:59], v[100:103], v[232:235], v[56:59]
    v_mfma_f32_16x16x32_bf16 v[60:63], v[100:103], v[236:239], v[60:63]
    s_waitcnt vmcnt(4)
    buffer_load_dwordx4 v[216:219], v123, s[68:71], s42 offen offset:0 sc1
    buffer_load_dwordx4 v[220:223], v123, s[68:71], s42 offen offset:1024 sc1
    s_waitcnt vmcnt(4)
    buffer_load_dwordx4 v[208:211], v122, s[68:71], s42 offen offset:0 sc1
    buffer_load_dwordx4 v[212:215], v122, s[68:71], s42 offen offset:1024 sc1
    s_add_u32 s42, s42, 4096
    s_cmp_ge_u32 s42, s43
    s_cselect_b32 s9, 45056, 0
    s_sub_u32 s42, s42, s9
    v_mfma_f32_16x16x32_bf16 v[64:67], v[104:107], v[232:235], v[64:67]
    v_mfma_f32_16x16x32_bf16 v[68:71], v[104:107], v[236:239], v[68:71]
    ds_read_b64_tr_b16 v[168:169], v12 offset:8192
    ds_read_b64_tr_b16 v[170:171], v12 offset:9216
    ds_read_b64_tr_b16 v[172:173], v119 offset:8192
    ds_read_b64_tr_b16 v[174:175], v119 offset:9216
    v_mfma_f32_16x16x32_bf16 v[72:75], v[108:111], v[232:235], v[72:75]
    v_mfma_f32_16x16x32_bf16 v[76:79], v[108:111], v[236:239], v[76:79]
    ds_read_b64_tr_b16 v[176:177], v6 offset:12288
    ds_read_b64_tr_b16 v[178:179], v6 offset:13312
    v_mfma_f32_16x16x32_bf16 v[16:19], v[96:99], v[224:227], v[16:19]
    v_mfma_f32_16x16x32_bf16 v[20:23], v[96:99], v[228:231], v[20:23]
    ds_read_b64_tr_b16 v[180:181], v11 offset:12288
    ds_read_b64_tr_b16 v[182:183], v11 offset:13312
    ds_read_b64_tr_b16 v[184:185], v12 offset:12288
    ds_read_b64_tr_b16 v[186:187], v12 offset:13312
    v_mfma_f32_16x16x32_bf16 v[24:27], v[100:103], v[224:227], v[24:27]
    v_mfma_f32_16x16x32_bf16 v[28:31], v[100:103], v[228:231], v[28:31]
    ds_read_b64_tr_b16 v[80:81], v124 offset:4096
    ds_read_b64_tr_b16 v[82:83], v124 offset:6144
    ds_read_b64_tr_b16 v[84:85], v125 offset:4096
    ds_read_b64_tr_b16 v[86:87], v125 offset:6144
    v_mfma_f32_16x16x32_bf16 v[32:35], v[104:107], v[224:227], v[32:35]
    v_mfma_f32_16x16x32_bf16 v[36:39], v[104:107], v[228:231], v[36:39]
    ds_read_b64_tr_b16 v[88:89], v126 offset:4096
    ds_read_b64_tr_b16 v[90:91], v126 offset:6144
    ds_read_b64_tr_b16 v[92:93], v127 offset:4096
    ds_read_b64_tr_b16 v[94:95], v127 offset:6144
    v_mfma_f32_16x16x32_bf16 v[40:43], v[108:111], v[224:227], v[40:43]
    v_mfma_f32_16x16x32_bf16 v[44:47], v[108:111], v[228:231], v[44:47]
    s_waitcnt lgkmcnt(0)
    v_mfma_f32_16x16x32_bf16 v[48:51], v[80:83], v[248:251], v[48:51]
    v_mfma_f32_16x16x32_bf16 v[52:55], v[80:83], v[252:255], v[52:55]
    s_waitcnt vmcnt(4)
    s_add_u32 m0, s25, 4096
    s_nop 0
    buffer_load_dwordx4 v120, s[52:55], s40 offen offset:0 lds
    buffer_load_dwordx4 v121, s[52:55], s40 offen offset:1024 lds
    s_add_u32 s40, s40, 16384
    s_waitcnt vmcnt(4)
    s_add_u32 m0, s25, 6144
    s_nop 0
    buffer_load_dwordx4 v120, s[52:55], s40 offen offset:0 lds
    buffer_load_dwordx4 v121, s[52:55], s40 offen offset:1024 lds
    s_add_u32 s40, s40, 16384
    s_cmp_ge_u32 s40, s41
    s_cselect_b32 s9, 360448, 0
    s_sub_u32 s40, s40, s9
    v_mfma_f32_16x16x32_bf16 v[56:59], v[84:87], v[248:251], v[56:59]
    v_mfma_f32_16x16x32_bf16 v[60:63], v[84:87], v[252:255], v[60:63]
    s_waitcnt vmcnt(4)
    buffer_load_dwordx4 v[232:235], v123, s[68:71], s42 offen offset:0 sc1
    buffer_load_dwordx4 v[236:239], v123, s[68:71], s42 offen offset:1024 sc1
    s_waitcnt vmcnt(4)
    buffer_load_dwordx4 v[224:227], v122, s[68:71], s42 offen offset:0 sc1
    buffer_load_dwordx4 v[228:231], v122, s[68:71], s42 offen offset:1024 sc1
    s_add_u32 s42, s42, 4096
    s_cmp_ge_u32 s42, s43
    s_cselect_b32 s9, 45056, 0
    s_sub_u32 s42, s42, s9
    v_mfma_f32_16x16x32_bf16 v[64:67], v[88:91], v[248:251], v[64:67]
    v_mfma_f32_16x16x32_bf16 v[68:71], v[88:91], v[252:255], v[68:71]
    ds_read_b64_tr_b16 v[188:189], v119 offset:12288
    ds_read_b64_tr_b16 v[190:191], v119 offset:13312
    ds_read_b64_tr_b16 v[192:193], v6 offset:16384
    ds_read_b64_tr_b16 v[194:195], v6 offset:17408
    v_mfma_f32_16x16x32_bf16 v[72:75], v[92:95], v[248:251], v[72:75]
    v_mfma_f32_16x16x32_bf16 v[76:79], v[92:95], v[252:255], v[76:79]
    ds_read_b64_tr_b16 v[196:197], v11 offset:16384
    ds_read_b64_tr_b16 v[198:199], v11 offset:17408
    v_mfma_f32_16x16x32_bf16 v[16:19], v[80:83], v[240:243], v[16:19]
    v_mfma_f32_16x16x32_bf16 v[20:23], v[80:83], v[244:247], v[20:23]
    ds_read_b64_tr_b16 v[200:201], v12 offset:16384
    ds_read_b64_tr_b16 v[202:203], v12 offset:17408
    ds_read_b64_tr_b16 v[204:205], v119 offset:16384
    ds_read_b64_tr_b16 v[206:207], v119 offset:17408
    v_mfma_f32_16x16x32_bf16 v[24:27], v[84:87], v[240:243], v[24:27]
    v_mfma_f32_16x16x32_bf16 v[28:31], v[84:87], v[244:247], v[28:31]
    ds_read_b64_tr_b16 v[96:97], v124 offset:0
    ds_read_b64_tr_b16 v[98:99], v124 offset:2048
    ds_read_b64_tr_b16 v[100:101], v125 offset:0
    ds_read_b64_tr_b16 v[102:103], v125 offset:2048
    v_mfma_f32_16x16x32_bf16 v[32:35], v[88:91], v[240:243], v[32:35]
    v_mfma_f32_16x16x32_bf16 v[36:39], v[88:91], v[244:247], v[36:39]
    ds_read_b64_tr_b16 v[104:105], v126 offset:0
    ds_read_b64_tr_b16 v[106:107], v126 offset:2048
    ds_read_b64_tr_b16 v[108:109], v127 offset:0
    ds_read_b64_tr_b16 v[110:111], v127 offset:2048
    v_mfma_f32_16x16x32_bf16 v[40:43], v[92:95], v[240:243], v[40:43]
    v_mfma_f32_16x16x32_bf16 v[44:47], v[92:95], v[244:247], v[44:47]
    s_waitcnt lgkmcnt(0)
    s_setprio 2
    s_branch L_spf_58
L_sp_56:
    s_sleep 1
L_spf_58:
    ds_read_b32 v1, v9 offset:120
    s_sub_u32 s10, s10, 1
    s_cmp_lt_i32 s10, 0
    s_cbranch_scc1 L_spd_57
    s_waitcnt lgkmcnt(0)
    v_readfirstlane_b32 s9, v1
    s_cmp_lt_u32 s9, 1
    s_cbranch_scc1 L_sp_56
L_spd_57:
    s_setprio 0
    v_mfma_f32_16x16x32_bf16 v[48:51], v[96:99], v[216:219], v[48:51]
    v_mfma_f32_16x16x32_bf16 v[52:55], v[96:99], v[220:223], v[52:55]
    s_waitcnt vmcnt(4)
    ds_read_b64_tr_b16 v[80:81], v124 offset:4096
    ds_read_b64_tr_b16 v[82:83], v124 offset:6144
    v_mfma_f32_16x16x32_bf16 v[56:59], v[100:103], v[216:219], v[56:59]
    v_mfma_f32_16x16x32_bf16 v[60:63], v[100:103], v[220:223], v[60:63]
    ds_read_b64_tr_b16 v[84:85], v125 offset:4096
    ds_read_b64_tr_b16 v[86:87], v125 offset:6144
    v_mfma_f32_16x16x32_bf16 v[64:67], v[104:107], v[216:219], v[64:67]
    v_mfma_f32_16x16x32_bf16 v[68:71], v[104:107], v[220:223], v[68:71]
    ds_read_b64_tr_b16 v[88:89], v126 offset:4096
    ds_read_b64_tr_b16 v[90:91], v126 offset:6144
    v_mfma_f32_16x16x32_bf16 v[72:75], v[108:111], v[216:219], v[72:75]
    v_mfma_f32_16x16x32_bf16 v[76:79], v[108:111], v[220:223], v[76:79]
    ds_read_b64_tr_b16 v[92:93], v127 offset:4096
    ds_read_b64_tr_b16 v[94:95], v127 offset:6144
    v_mfma_f32_16x16x32_bf16 v[16:19], v[96:99], v[208:211], v[16:19]
    v_mfma_f32_16x16x32_bf16 v[20:23], v[96:99], v[212:215], v[20:23]
    v_mfma_f32_16x16x32_bf16 v[24:27], v[100:103], v[208:211], v[24:27]
    v_mfma_f32_16x16x32_bf16 v[28:31], v[100:103], v[212:215], v[28:31]
    v_mfma_f32_16x16x32_bf16 v[32:35], v[104:107], v[208:211], v[32:35]
    v_mfma_f32_16x16x32_bf16 v[36:39], v[104:107], v[212:215], v[36:39]
    v_mfma_f32_16x16x32_bf16 v[40:43], v[108:111], v[208:211], v[40:43]
    v_mfma_f32_16x16x32_bf16 v[44:47], v[108:111], v[212:215], v[44:47]
    s_waitcnt lgkmcnt(0)
    s_waitcnt vmcnt(0)
    v_mfma_f32_16x16x32_bf16 v[48:51], v[80:83], v[232:235], v[48:51]
    v_mfma_f32_16x16x32_bf16 v[52:55], v[80:83], v[236:239], v[52:55]
    v_mfma_f32_16x16x32_bf16 v[56:59], v[84:87], v[232:235], v[56:59]
    v_mfma_f32_16x16x32_bf16 v[60:63], v[84:87], v[236:239], v[60:63]
    v_mfma_f32_16x16x32_bf16 v[64:67], v[88:91], v[232:235], v[64:67]
    v_mfma_f32_16x16x32_bf16 v[68:71], v[88:91], v[236:239], v[68:71]
    v_mfma_f32_16x16x32_bf16 v[72:75], v[92:95], v[232:235], v[72:75]
    v_mfma_f32_16x16x32_bf16 v[76:79], v[92:95], v[236:239], v[76:79]
    v_mfma_f32_16x16x32_bf16 v[16:19], v[80:83], v[224:227], v[16:19]
    ds_write_b128 v14, v[48:51] offset:0
    v_mfma_f32_16x16x32_bf16 v[20:23], v[80:83], v[228:231], v[20:23]
    ds_write_b128 v14, v[52:55] offset:1024
    v_mfma_f32_16x16x32_bf16 v[24:27], v[84:87], v[224:227], v[24:27]
    ds_write_b128 v14, v[56:59] offset:2048
    v_mfma_f32_16x16x32_bf16 v[28:31], v[84:87], v[228:231], v[28:31]
    ds_write_b128 v14, v[60:63] offset:3072
    v_mfma_f32_16x16x32_bf16 v[32:35], v[88:91], v[224:227], v[32:35]
    ds_write_b128 v14, v[64:67] offset:4096
    v_mfma_f32_16x16x32_bf16 v[36:39], v[88:91], v[228:231], v[36:39]
    ds_write_b128 v14, v[68:71] offset:5120
    v_mfma_f32_16x16x32_bf16 v[40:43], v[92:95], v[224:227], v[40:43]
    ds_write_b128 v14, v[72:75] offset:6144
    v_mfma_f32_16x16x32_bf16 v[44:47], v[92:95], v[228:231], v[44:47]
    ds_write_b128 v14, v[76:79] offset:7168
    s_setprio 2
    s_waitcnt lgkmcnt(0)
    s_barrier
    buffer_load_dwordx4 v[48:51], v5, s[64:67], s4 offen offset:0 sc1
    buffer_load_dwordx4 v[52:55], v5, s[64:67], s4 offen offset:2048 sc1
    buffer_load_dwordx4 v[56:59], v5, s[64:67], s5 offen offset:0 sc1
    buffer_load_dwordx4 v[60:63], v5, s[64:67], s5 offen offset:2048 sc1
    buffer_load_dwordx4 v[64:67], v5, s[64:67], s6 offen offset:0 sc1
    buffer_load_dwordx4 v[68:71], v5, s[64:67], s6 offen offset:2048 sc1
    buffer_load_dwordx4 v[72:75], v5, s[64:67], s7 offen offset:0 sc1
    buffer_load_dwordx4 v[76:79], v5, s[64:67], s7 offen offset:2048 sc1
    ds_read_b128 v[80:83], v13 offset:0
    ds_read_b128 v[84:87], v13 offset:1024
    ds_read_b128 v[88:91], v13 offset:2048
    ds_read_b128 v[92:95], v13 offset:3072
    ds_read_b128 v[96:99], v13 offset:4096
    ds_read_b128 v[100:103], v13 offset:5120
    ds_read_b128 v[104:107], v13 offset:6144
    ds_read_b128 v[108:111], v13 offset:7168
    ds_read_b64_tr_b16 v[208:209], v6 offset:20480
    ds_read_b64_tr_b16 v[210:211], v6 offset:21504
    ds_read_b64_tr_b16 v[212:213], v11 offset:20480
    ds_read_b64_tr_b16 v[214:215], v11 offset:21504
    ds_read_b64_tr_b16 v[216:217], v12 offset:20480
    ds_read_b64_tr_b16 v[218:219], v12 offset:21504
    ds_read_b64_tr_b16 v[220:221], v119 offset:20480
    ds_read_b64_tr_b16 v[222:223], v119 offset:21504
    v_lshlrev_b32 v120, 16, v112
    v_and_b32 v121, 0xffff0000, v112
    v_lshlrev_b32 v122, 16, v113
    v_and_b32 v123, 0xffff0000, v113
    v_lshlrev_b32 v124, 16, v114
    v_and_b32 v125, 0xffff0000, v114
    v_lshlrev_b32 v126, 16, v115
    v_and_b32 v127, 0xffff0000, v115
    s_waitcnt lgkmcnt(14)
    v_pk_add_f32 v[16:17], v[16:17], v[80:81]
    v_pk_add_f32 v[18:19], v[18:19], v[82:83]
    v_pk_add_f32 v[20:21], v[20:21], v[84:85]
    v_pk_add_f32 v[22:23], v[22:23], v[86:87]
    s_waitcnt lgkmcnt(12)
    v_pk_add_f32 v[24:25], v[24:25], v[88:89]
    v_pk_add_f32 v[26:27], v[26:27], v[90:91]
    v_pk_add_f32 v[28:29], v[28:29], v[92:93]
    v_pk_add_f32 v[30:31], v[30:31], v[94:95]
    s_waitcnt lgkmcnt(10)
    v_pk_add_f32 v[32:33], v[32:33], v[96:97]
    v_pk_add_f32 v[34:35], v[34:35], v[98:99]
    v_pk_add_f32 v[36:37], v[36:37], v[100:101]
    v_pk_add_f32 v[38:39], v[38:39], v[102:103]
    s_waitcnt lgkmcnt(8)
    v_pk_add_f32 v[40:41], v[40:41], v[104:105]
    v_pk_add_f32 v[42:43], v[42:43], v[106:107]
    v_pk_add_f32 v[44:45], v[44:45], v[108:109]
    v_pk_add_f32 v[46:47], v[46:47], v[110:111]
    ds_read_b64_tr_b16 v[224:225], v6 offset:24576
    ds_read_b64_tr_b16 v[226:227], v6 offset:25600
    ds_read_b64_tr_b16 v[228:229], v11 offset:24576
    ds_read_b64_tr_b16 v[230:231], v11 offset:25600
    ds_read_b64_tr_b16 v[232:233], v12 offset:24576
    ds_read_b64_tr_b16 v[234:235], v12 offset:25600
    ds_read_b64_tr_b16 v[236:237], v119 offset:24576
    ds_read_b64_tr_b16 v[238:239], v119 offset:25600
    ds_read_b64_tr_b16 v[240:241], v6 offset:28672
    ds_read_b64_tr_b16 v[242:243], v6 offset:29696
    ds_read_b64_tr_b16 v[244:245], v11 offset:28672
    ds_read_b64_tr_b16 v[246:247], v11 offset:29696
    ds_read_b64_tr_b16 v[248:249], v12 offset:28672
    ds_read_b64_tr_b16 v[250:251], v12 offset:29696
    ds_read_b64_tr_b16 v[252:253], v119 offset:28672
    ds_read_b64_tr_b16 v[254:255], v119 offset:29696
    v_lshl_add_u32 v119, s11, 2, v9
    buffer_load_dwordx4 v[80:83], v5, s[64:67], s4 offen offset:256 sc1
    buffer_load_dwordx4 v[84:87], v5, s[64:67], s4 offen offset:2304 sc1
    buffer_load_dwordx4 v[88:91], v5, s[64:67], s5 offen offset:256 sc1
    s_waitcnt lgkmcnt(0)
    s_waitcnt vmcnt(9)
    v_max_u32 v7, v48, v52
    v_cmp_eq_u32 vcc, -1, v7
    s_cbranch_vccnz L_or_60
L_ok_61:
    v_mfma_f32_16x16x32_bf16 v[16:19], v[128:131], v[48:51], v[16:19]
    buffer_load_dwordx4 v[92:95], v5, s[64:67], s5 offen offset:2304 sc1
    v_mfma_f32_16x16x32_bf16 v[24:27], v[132:135], v[48:51], v[24:27]
    v_mfma_f32_16x16x32_bf16 v[32:35], v[136:139], v[48:51], v[32:35]
    buffer_load_dwordx4 v[96:99], v5, s[64:67], s6 offen offset:256 sc1
    v_mfma_f32_16x16x32_bf16 v[40:43], v[140:143], v[48:51], v[40:43]
    v_mfma_f32_16x16x32_bf16 v[16:19], v[144:147], v[52:55], v[16:19]
    v_mfma_f32_16x16x32_bf16 v[24:27], v[148:151], v[52:55], v[24:27]
    s_waitcnt vmcnt(9)
    v_max_u32 v7, v56, v60
    v_mfma_f32_16x16x32_bf16 v[32:35], v[152:155], v[52:55], v[32:35]
    v_cmp_eq_u32 vcc, -1, v7
    v_mfma_f32_16x16x32_bf16 v[40:43], v[156:159], v[52:55], v[40:43]
    s_cbranch_vccnz L_or_63
L_ok_64:
    v_mfma_f32_16x16x32_bf16 v[16:19], v[160:163], v[56:59], v[16:19]
    buffer_load_dwordx4 v[100:103], v5, s[64:67], s6 offen offset:2304 sc1
    v_mfma_f32_16x16x32_bf16 v[24:27], v[164:167], v[56:59], v[24:27]
    v_mfma_f32_16x16x32_bf16 v[32:35], v[168:171], v[56:59], v[32:35]
    buffer_load_dwordx4 v[104:107], v5, s[64:67], s7 offen offset:256 sc1
    v_mfma_f32_16x16x32_bf16 v[40:43], v[172:175], v[56:59], v[40:43]
    v_mfma_f32_16x16x32_bf16 v[16:19], v[176:179], v[60:63], v[16:19]
    v_mfma_f32_16x16x32_bf16 v[24:27], v[180:183], v[60:63], v[24:27]
    s_waitcnt vmcnt(9)
    v_max_u32 v7, v64, v68
    v_mfma_f32_16x16x32_bf16 v[32:35], v[184:187], v[60:63], v[32:35]
    v_cmp_eq_u32 vcc, -1, v7
    v_mfma_f32_16x16x32_bf16 v[40:43], v[188:191], v[60:63], v[40:43]
    s_cbranch_vccnz L_or_66
L_ok_67:
    v_mfma_f32_16x16x32_bf16 v[16:19], v[192:195], v[64:67], v[16:19]
    buffer_load_dwordx4 v[108:111], v5, s[64:67], s7 offen offset:2304 sc1
    v_mfma_f32_16x16x32_bf16 v[24:27], v[196:199], v[64:67], v[24:27]
    v_mfma_f32_16x16x32_bf16 v[32:35], v[200:203], v[64:67], v[32:35]
    v_mfma_f32_16x16x32_bf16 v[40:43], v[204:207], v[64:67], v[40:43]
    v_mfma_f32_16x16x32_bf16 v[16:19], v[208:211], v[68:71], v[16:19]
    v_mfma_f32_16x16x32_bf16 v[24:27], v[212:215], v[68:71], v[24:27]
    s_waitcnt vmcnt(8)
    v_max_u32 v7, v72, v76
    v_mfma_f32_16x16x32_bf16 v[32:35], v[216:219], v[68:71], v[32:35]
    v_cmp_eq_u32 vcc, -1, v7
    v_mfma_f32_16x16x32_bf16 v[40:43], v[220:223], v[68:71], v[40:43]
    s_cbranch_vccnz L_or_69
L_ok_70:
    v_mfma_f32_16x16x32_bf16 v[16:19], v[224:227], v[72:75], v[16:19]
    v_mfma_f32_16x16x32_bf16 v[24:27], v[228:231], v[72:75], v[24:27]
    v_mfma_f32_16x16x32_bf16 v[32:35], v[232:235], v[72:75], v[32:35]
    v_mfma_f32_16x16x32_bf16 v[40:43], v[236:239], v[72:75], v[40:43]
    v_mfma_f32_16x16x32_bf16 v[16:19], v[240:243], v[76:79], v[16:19]
    v_mfma_f32_16x16x32_bf16 v[24:27], v[244:247], v[76:79], v[24:27]
    s_waitcnt vmcnt(6)
    v_max_u32 v7, v80, v84
    v_mfma_f32_16x16x32_bf16 v[32:35], v[248:251], v[76:79], v[32:35]
    v_cmp_eq_u32 vcc, -1, v7
    v_mfma_f32_16x16x32_bf16 v[40:43], v[252:255], v[76:79], v[40:43]
    s_cbranch_vccnz L_or_72
L_ok_73:
    v_mfma_f32_16x16x32_bf16 v[20:23], v[128:131], v[80:83], v[20:23]
    v_mfma_f32_16x16x32_bf16 v[28:31], v[132:135], v[80:83], v[28:31]
    v_mfma_f32_16x16x32_bf16 v[36:39], v[136:139], v[80:83], v[36:39]
    v_mfma_f32_16x16x32_bf16 v[44:47], v[140:143], v[80:83], v[44:47]
    v_mfma_f32_16x16x32_bf16 v[20:23], v[144:147], v[84:87], v[20:23]
    ds_write_b128 v4, v[16:19] offset:0
    v_mfma_f32_16x16x32_bf16 v[28:31], v[148:151], v[84:87], v[28:31]
    ds_write_b128 v4, v[24:27] offset:64
    s_waitcnt vmcnt(4)
    v_max_u32 v7, v88, v92
    v_mfma_f32_16x16x32_bf16 v[36:39], v[152:155], v[84:87], v[36:39]
    v_cmp_eq_u32 vcc, -1, v7
    v_mfma_f32_16x16x32_bf16 v[44:47], v[156:159], v[84:87], v[44:47]
    s_cbranch_vccnz L_or_75
L_ok_76:
    v_mfma_f32_16x16x32_bf16 v[20:23], v[160:163], v[88:91], v[20:23]
    ds_write_b128 v4, v[32:35] offset:128
    v_mfma_f32_16x16x32_bf16 v[28:31], v[164:167], v[88:91], v[28:31]
    v_mfma_f32_16x16x32_bf16 v[36:39], v[168:171], v[88:91], v[36:39]
    ds_write_b128 v4, v[40:43] offset:192
    v_mfma_f32_16x16x32_bf16 v[44:47], v[172:175], v[88:91], v[44:47]
    s_mov_b64 exec, 1
    ds_add_u32 v9, v2 offset:124
    s_mov_b64 exec, -1
    v_mfma_f32_16x16x32_bf16 v[20:23], v[176:179], v[92:95], v[20:23]
    v_mfma_f32_16x16x32_bf16 v[28:31], v[180:183], v[92:95], v[28:31]
    s_waitcnt vmcnt(2)
    v_max_u32 v7, v96, v100
    v_mfma_f32_16x16x32_bf16 v[36:39], v[184:187], v[92:95], v[36:39]
    v_cmp_eq_u32 vcc, -1, v7
    v_mfma_f32_16x16x32_bf16 v[44:47], v[188:191], v[92:95], v[44:47]
    s_cbranch_vccnz L_or_78
L_ok_79:
    v_mfma_f32_16x16x32_bf16 v[20:23], v[192:195], v[96:99], v[20:23]
    v_mfma_f32_16x16x32_bf16 v[28:31], v[196:199], v[96:99], v[28:31]
    v_mfma_f32_16x16x32_bf16 v[36:39], v[200:203], v[96:99], v[36:39]
    v_mfma_f32_16x16x32_bf16 v[44:47], v[204:207], v[96:99], v[44:47]
    v_mfma_f32_16x16x32_bf16 v[20:23], v[208:211], v[100:103], v[20:23]
    v_mfma_f32_16x16x32_bf16 v[28:31], v[212:215], v[100:103], v[28:31]
    s_waitcnt vmcnt(0)
    v_max_u32 v7, v104, v108
    v_mfma_f32_16x16x32_bf16 v[36:39], v[216:219], v[100:103], v[36:39]
    v_cmp_eq_u32 vcc, -1, v7
    v_mfma_f32_16x16x32_bf16 v[44:47], v[220:223], v[100:103], v[44:47]
    s_cbranch_vccnz L_or_81
L_ok_82:
    v_mfma_f32_16x16x32_bf16 v[20:23], v[224:227], v[104:107], v[20:23]
    v_mfma_f32_16x16x32_bf16 v[28:31], v[228:231], v[104:107], v[28:31]
    v_mfma_f32_16x16x32_bf16 v[36:39], v[232:235], v[104:107], v[36:39]
    v_mfma_f32_16x16x32_bf16 v[44:47], v[236:239], v[104:107], v[44:47]
    v_mfma_f32_16x16x32_bf16 v[20:23], v[240:243], v[108:111], v[20:23]
    v_mfma_f32_16x16x32_bf16 v[28:31], v[244:247], v[108:111], v[28:31]
    v_mfma_f32_16x16x32_bf16 v[36:39], v[248:251], v[108:111], v[36:39]
    v_mfma_f32_16x16x32_bf16 v[44:47], v[252:255], v[108:111], v[44:47]
    s_nop 4
    ds_write_b128 v4, v[20:23] offset:4352
    ds_write_b128 v4, v[28:31] offset:4416
    ds_write_b128 v4, v[36:39] offset:4480
    ds_write_b128 v4, v[44:47] offset:4544
    s_mov_b64 exec, 1
    ds_add_u32 v10, v2 offset:128
    s_mov_b64 exec, -1
L_sp_83:
    ds_read_b32 v1, v119 offset:128
L_pgg4:
    s_cbranch_execz L_rtg4
    s_sub_u32 s10, s10, 1
    s_cmp_lt_i32 s10, 0
    s_cbranch_scc1 L_spd_84
    s_waitcnt lgkmcnt(0)
    v_readfirstlane_b32 s9, v1
    s_cmp_lt_u32 s9, 2
    s_cbranch_scc1 L_sp_83
L_spd_84:
    ds_read_b128 v[48:51], v116 offset:0
    ds_read_b128 v[56:59], v116 offset:17408
    ds_read_b128 v[52:55], v116 offset:16
    ds_read_b128 v[60:63], v116 offset:17424
    s_waitcnt lgkmcnt(3)
    v_pk_add_f32 v[120:121], v[120:121], v[48:49]
    v_pk_add_f32 v[122:123], v[122:123], v[50:51]
    s_waitcnt lgkmcnt(2)
    v_pk_add_f32 v[120:121], v[120:121], v[56:57]
    v_pk_add_f32 v[122:123], v[122:123], v[58:59]
    v_cvt_pk_bf16_f32 v64, v120, v121
    v_cvt_pk_bf16_f32 v65, v122, v123
    s_waitcnt lgkmcnt(1)
    v_pk_add_f32 v[124:125], v[124:125], v[52:53]
    v_pk_add_f32 v[126:127], v[126:127], v[54:55]
    s_waitcnt lgkmcnt(0)
    v_pk_add_f32 v[124:125], v[124:125], v[60:61]
    v_pk_add_f32 v[126:127], v[126:127], v[62:63]
    v_cvt_pk_bf16_f32 v66, v124, v125
    v_cvt_pk_bf16_f32 v67, v126, v127
    buffer_store_dwordx4 v[64:67], v117, s[60:63], s20 offen sc1
L_end:
    s_endpgm
L_or_60:
    s_sub_u32 s10, s10, 1
    s_cmp_lt_i32 s10, 0
    s_cbranch_scc1 L_ok_61
    buffer_load_dwordx4 v[48:51], v5, s[64:67], s4 offen offset:0 sc1
    buffer_load_dwordx4 v[52:55], v5, s[64:67], s4 offen offset:2048 sc1
    s_waitcnt vmcnt(0)
    v_max_u32 v7, v48, v52
    v_cmp_eq_u32 vcc, -1, v7
    s_cbranch_vccnz L_or_60
    s_branch L_ok_61
L_or_63:
    s_sub_u32 s10, s10, 1
    s_cmp_lt_i32 s10, 0
    s_cbranch_scc1 L_ok_64
    buffer_load_dwordx4 v[56:59], v5, s[64:67], s5 offen offset:0 sc1
    buffer_load_dwordx4 v[60:63], v5, s[64:67], s5 offen offset:2048 sc1
    s_waitcnt vmcnt(0)
    v_max_u32 v7, v56, v60
    v_cmp_eq_u32 vcc, -1, v7
    s_cbranch_vccnz L_or_63
    s_branch L_ok_64
L_or_66:
    s_sub_u32 s10, s10, 1
    s_cmp_lt_i32 s10, 0
    s_cbranch_scc1 L_ok_67
    buffer_load_dwordx4 v[64:67], v5, s[64:67], s6 offen offset:0 sc1
    buffer_load_dwordx4 v[68:71], v5, s[64:67], s6 offen offset:2048 sc1
    s_waitcnt vmcnt(0)
    v_max_u32 v7, v64, v68
    v_cmp_eq_u32 vcc, -1, v7
    s_cbranch_vccnz L_or_66
    s_branch L_ok_67
L_or_69:
    s_sub_u32 s10, s10, 1
    s_cmp_lt_i32 s10, 0
    s_cbranch_scc1 L_ok_70
    buffer_load_dwordx4 v[72:75], v5, s[64:67], s7 offen offset:0 sc1
    buffer_load_dwordx4 v[76:79], v5, s[64:67], s7 offen offset:2048 sc1
    s_waitcnt vmcnt(0)
    v_max_u32 v7, v72, v76
    v_cmp_eq_u32 vcc, -1, v7
    s_cbranch_vccnz L_or_69
    s_branch L_ok_70
L_or_72:
    s_sub_u32 s10, s10, 1
    s_cmp_lt_i32 s10, 0
    s_cbranch_scc1 L_ok_73
    buffer_load_dwordx4 v[80:83], v5, s[64:67], s4 offen offset:256 sc1
    buffer_load_dwordx4 v[84:87], v5, s[64:67], s4 offen offset:2304 sc1
    s_waitcnt vmcnt(0)
    v_max_u32 v7, v80, v84
    v_cmp_eq_u32 vcc, -1, v7
    s_cbranch_vccnz L_or_72
    s_branch L_ok_73
L_or_75:
    s_sub_u32 s10, s10, 1
    s_cmp_lt_i32 s10, 0
    s_cbranch_scc1 L_ok_76
    buffer_load_dwordx4 v[88:91], v5, s[64:67], s5 offen offset:256 sc1
    buffer_load_dwordx4 v[92:95], v5, s[64:67], s5 offen offset:2304 sc1
    s_waitcnt vmcnt(0)
    v_max_u32 v7, v88, v92
    v_cmp_eq_u32 vcc, -1, v7
    s_cbranch_vccnz L_or_75
    s_branch L_ok_76
L_or_78:
    s_sub_u32 s10, s10, 1
    s_cmp_lt_i32 s10, 0
    s_cbranch_scc1 L_ok_79
    buffer_load_dwordx4 v[96:99], v5, s[64:67], s6 offen offset:256 sc1
    buffer_load_dwordx4 v[100:103], v5, s[64:67], s6 offen offset:2304 sc1
    s_waitcnt vmcnt(0)
    v_max_u32 v7, v96, v100
    v_cmp_eq_u32 vcc, -1, v7
    s_cbranch_vccnz L_or_78
    s_branch L_ok_79
L_or_81:
    s_sub_u32 s10, s10, 1
    s_cmp_lt_i32 s10, 0
    s_cbranch_scc1 L_ok_82
    buffer_load_dwordx4 v[104:107], v5, s[64:67], s7 offen offset:256 sc1
    buffer_load_dwordx4 v[108:111], v5, s[64:67], s7 offen offset:2304 sc1
    s_waitcnt vmcnt(0)
    v_max_u32 v7, v104, v108
    v_cmp_eq_u32 vcc, -1, v7
    s_cbranch_vccnz L_or_81
    s_branch L_ok_82
L_slow0:
    v_mov_b32 v96, 0xff800000
    v_mov_b32 v224, 0
    v_mov_b32 v225, 0
    v_mov_b32 v226, 0
    v_mov_b32 v227, 0
    v_mov_b32 v228, 0
    v_mov_b32 v229, 0
    v_mov_b32 v230, 0
    v_mov_b32 v231, 0
    v_mov_b32 v232, 0
    v_mov_b32 v233, 0
    v_mov_b32 v234, 0
    v_mov_b32 v235, 0
    v_mov_b32 v236, 0
    v_mov_b32 v237, 0
    v_mov_b32 v238, 0
    v_mov_b32 v239, 0
    v_mov_b32 v88, 0x3f803f80
    v_mov_b32 v89, 0x3f803f80
    v_mov_b32 v90, 0x3f803f80
    v_mov_b32 v91, 0x3f803f80
    v_mov_b32 v92, 0x3f803f80
    v_mov_b32 v93, 0x3f803f80
    v_mov_b32 v94, 0x3f803f80
    v_mov_b32 v95, 0x3f803f80
    s_mov_b32 s4, 0
    s_waitcnt vmcnt(0) lgkmcnt(0)
L_s1_86:
    buffer_load_dwordx4 v[84:87], v8, s[64:67], s4 offen sc1
    s_waitcnt vmcnt(0)
    v_mfma_f32_32x32x16_bf16 v[48:63], v[84:87], v[40:43], 0
    s_nop 15
    v_max3_f32 v96, v96, v48, v49
    v_max3_f32 v96, v96, v50, v51
    v_max3_f32 v96, v96, v52, v53
    v_max3_f32 v96, v96, v54, v55
    v_max3_f32 v96, v96, v56, v57
    v_max3_f32 v96, v96, v58, v59
    v_max3_f32 v96, v96, v60, v61
    v_max3_f32 v96, v96, v62, v63
    s_add_u32 s4, s4, 2048
    s_cmp_lt_u32 s4, 131072
    s_cbranch_scc1 L_s1_86
    v_mov_b32 v97, v96
    s_nop 1
    v_permlane32_swap_b32 v96, v97
    s_nop 1
    v_max_f32 v96, v96, v97
    s_mov_b32 s4, 0
L_s2_87:
    buffer_load_dwordx4 v[84:87], v8, s[64:67], s4 offen sc1
    s_mov_b64 exec, s[16:17]
    buffer_load_dwordx4 v[88:91], v11, s[64:67], s4 offen offset:1024 sc1
    buffer_load_dwordx4 v[92:95], v11, s[64:67], s4 offen offset:1536 sc1
    s_mov_b64 exec, -1
    s_waitcnt vmcnt(0)
    v_mfma_f32_32x32x16_bf16 v[48:63], v[84:87], v[40:43], 0
    s_nop 15
    v_sub_f32 v48, v48, v96
    v_sub_f32 v49, v49, v96
    v_sub_f32 v50, v50, v96
    v_sub_f32 v51, v51, v96
    v_sub_f32 v52, v52, v96
    v_sub_f32 v53, v53, v96
    v_sub_f32 v54, v54, v96
    v_sub_f32 v55, v55, v96
    v_sub_f32 v56, v56, v96
    v_sub_f32 v57, v57, v96
    v_sub_f32 v58, v58, v96
    v_sub_f32 v59, v59, v96
    v_sub_f32 v60, v60, v96
    v_sub_f32 v61, v61, v96
    v_sub_f32 v62, v62, v96
    v_sub_f32 v63, v63, v96
    v_exp_f32 v48, v48
    v_exp_f32 v49, v49
    v_exp_f32 v50, v50
    v_exp_f32 v51, v51
    v_exp_f32 v52, v52
    v_exp_f32 v53, v53
    v_exp_f32 v54, v54
    v_exp_f32 v55, v55
    v_exp_f32 v56, v56
    v_exp_f32 v57, v57
    v_exp_f32 v58, v58
    v_exp_f32 v59, v59
    v_exp_f32 v60, v60
    v_exp_f32 v61, v61
    v_exp_f32 v62, v62
    v_exp_f32 v63, v63
    s_nop 1
    v_smfmac_f32_32x32x32_bf16 v[224:239], v[88:91], v[48:55], v3
    v_smfmac_f32_32x32x32_bf16 v[224:239], v[92:95], v[56:63], v3
    s_nop 15
    s_add_u32 s4, s4, 2048
    s_cmp_lt_u32 s4, 131072
    s_cbranch_scc1 L_s2_87
    v_rcp_f32 v232, v232
    s_nop 0
    s_branch L_norm0
L_slow1:
    v_mov_b32 v96, 0xff800000
    v_mov_b32 v240, 0
    v_mov_b32 v241, 0
    v_mov_b32 v242, 0
    v_mov_b32 v243, 0
    v_mov_b32 v244, 0
    v_mov_b32 v245, 0
    v_mov_b32 v246, 0
    v_mov_b32 v247, 0
    v_mov_b32 v248, 0
    v_mov_b32 v249, 0
    v_mov_b32 v250, 0
    v_mov_b32 v251, 0
    v_mov_b32 v252, 0
    v_mov_b32 v253, 0
    v_mov_b32 v254, 0
    v_mov_b32 v255, 0
    v_mov_b32 v88, 0x3f803f80
    v_mov_b32 v89, 0x3f803f80
    v_mov_b32 v90, 0x3f803f80
    v_mov_b32 v91, 0x3f803f80
    v_mov_b32 v92, 0x3f803f80
    v_mov_b32 v93, 0x3f803f80
    v_mov_b32 v94, 0x3f803f80
    v_mov_b32 v95, 0x3f803f80
    s_mov_b32 s4, 0
    s_waitcnt vmcnt(0) lgkmcnt(0)
L_s1_88:
    buffer_load_dwordx4 v[84:87], v8, s[64:67], s4 offen sc1
    s_waitcnt vmcnt(0)
    v_mfma_f32_32x32x16_bf16 v[48:63], v[84:87], v[44:47], 0
    s_nop 15
    v_max3_f32 v96, v96, v48, v49
    v_max3_f32 v96, v96, v50, v51
    v_max3_f32 v96, v96, v52, v53
    v_max3_f32 v96, v96, v54, v55
    v_max3_f32 v96, v96, v56, v57
    v_max3_f32 v96, v96, v58, v59
    v_max3_f32 v96, v96, v60, v61
    v_max3_f32 v96, v96, v62, v63
    s_add_u32 s4, s4, 2048
    s_cmp_lt_u32 s4, 131072
    s_cbranch_scc1 L_s1_88
    v_mov_b32 v97, v96
    s_nop 1
    v_permlane32_swap_b32 v96, v97
    s_nop 1
    v_max_f32 v96, v96, v97
    s_mov_b32 s4, 0
L_s2_89:
    buffer_load_dwordx4 v[84:87], v8, s[64:67], s4 offen sc1
    s_mov_b64 exec, s[16:17]
    buffer_load_dwordx4 v[88:91], v11, s[64:67], s4 offen offset:1024 sc1
    buffer_load_dwordx4 v[92:95], v11, s[64:67], s4 offen offset:1536 sc1
    s_mov_b64 exec, -1
    s_waitcnt vmcnt(0)
    v_mfma_f32_32x32x16_bf16 v[48:63], v[84:87], v[44:47], 0
    s_nop 15
    v_sub_f32 v48, v48, v96
    v_sub_f32 v49, v49, v96
    v_sub_f32 v50, v50, v96
    v_sub_f32 v51, v51, v96
    v_sub_f32 v52, v52, v96
    v_sub_f32 v53, v53, v96
    v_sub_f32 v54, v54, v96
    v_sub_f32 v55, v55, v96
    v_sub_f32 v56, v56, v96
    v_sub_f32 v57, v57, v96
    v_sub_f32 v58, v58, v96
    v_sub_f32 v59, v59, v96
    v_sub_f32 v60, v60, v96
    v_sub_f32 v61, v61, v96
    v_sub_f32 v62, v62, v96
    v_sub_f32 v63, v63, v96
    v_exp_f32 v48, v48
    v_exp_f32 v49, v49
    v_exp_f32 v50, v50
    v_exp_f32 v51, v51
    v_exp_f32 v52, v52
    v_exp_f32 v53, v53
    v_exp_f32 v54, v54
    v_exp_f32 v55, v55
    v_exp_f32 v56, v56
    v_exp_f32 v57, v57
    v_exp_f32 v58, v58
    v_exp_f32 v59, v59
    v_exp_f32 v60, v60
    v_exp_f32 v61, v61
    v_exp_f32 v62, v62
    v_exp_f32 v63, v63
    s_nop 1
    v_smfmac_f32_32x32x32_bf16 v[240:255], v[88:91], v[48:55], v3
    v_smfmac_f32_32x32x32_bf16 v[240:255], v[92:95], v[56:63], v3
    s_nop 15
    s_add_u32 s4, s4, 2048
    s_cmp_lt_u32 s4, 131072
    s_cbranch_scc1 L_s2_89
    v_rcp_f32 v248, v248
    s_nop 0
    s_branch L_norm1
L_last:
    s_endpgm
.section .rodata,"a"
.p2align 6
.amdhsa_kernel parallel_sum__grouped_kv_mqa__dense_activation_silu__prompt_kernel
  .amdhsa_next_free_vgpr 256
  .amdhsa_next_free_sgpr 102
  .amdhsa_accum_offset 256
  .amdhsa_group_segment_fixed_size 0
  .amdhsa_kernarg_size 88
  .amdhsa_user_sgpr_count 2
  .amdhsa_user_sgpr_kernarg_segment_ptr 1
  .amdhsa_system_sgpr_workgroup_id_x 1
.end_amdhsa_kernel
```
